```python
import torch

def _softmax(x, axis=-1):
    return torch.softmax(x, dim=axis)
def _gelu(x):
    return torch.nn.functional.gelu(x, approximate="tanh")
def _silu(x):
    return torch.nn.functional.silu(x)
def _sigmoid(x):
    return torch.sigmoid(x)
def _layernorm(x, axis=-1, eps=1e-5):
    m = x.mean(dim=axis, keepdim=True)
    v = x.var(dim=axis, keepdim=True, unbiased=False)
    return (x - m) / torch.sqrt(v + eps)
def _scatter_add(tgt, idx, src, axis=0):
    return tgt.clone().index_add_(axis, idx, src)
def _segment_sum(src, seg, n):
    out = torch.zeros((n,) + src.shape[1:], dtype=src.dtype)
    return out.index_add_(0, seg, src)
def _pad(x, pw):
    flat = tuple(v for pair in reversed(pw) for v in pair)
    return torch.nn.functional.pad(x, flat)

kernel_name = 'standalone__gqa_softmax__near_ridge'

def setup_inputs():

    _w = (lambda a: (lambda t: t.to(torch.bfloat16) if t.is_floating_point() else t)(torch.as_tensor(a)))
    B, Hq, Hkv, Sq, Sk, D = 8, 16, 8, 384, 512, 256
    return {
        "q": _w((lambda *s: torch.randn(*s, dtype=torch.bfloat16) * 0.8)(B, Hq, Sq, D)),
        "k": _w((lambda *s: torch.randn(*s, dtype=torch.bfloat16) * 0.8)(B, Hkv, Sk, D)),
        "v": _w((lambda *s: torch.randn(*s, dtype=torch.bfloat16) * 0.05)(B, Hkv, Sk, D)),
    }

def reference(q, k, v):
    B, Hq, Sq, D = q.shape
    Hkv = k.shape[1]
    rep = Hq // Hkv
    k = (lambda x, n, axis: torch.repeat_interleave(x, n, dim=axis))(k, rep, axis=1)
    v = (lambda x, n, axis: torch.repeat_interleave(x, n, dim=axis))(v, rep, axis=1)
    scale = D ** -0.5
    scores = torch.einsum("bhqd,bhkd->bhqk", q, k) * scale
    p = _softmax(scores, axis=-1)
    return torch.einsum("bhqk,bhkd->bhqd", p, v)
```

```asm
; @launch grid=(256,1,1) block=(256,1,1) lds=163840
.amdgcn_target "amdgcn-amd-amdhsa--gfx950"
.text
.globl standalone__gqa_softmax__near_ridge_kernel
.p2align 8
.type standalone__gqa_softmax__near_ridge_kernel,@function
standalone__gqa_softmax__near_ridge_kernel:
    s_cmp_ge_u32 s2, 256
    s_cbranch_scc1 L_end
    s_load_dwordx4 s[36:39], s[0:1], 0
    s_load_dwordx4 s[40:43], s[0:1], 16
    s_getpc_b64 s[50:51]
    v_lshlrev_b32 v1, 4, v0
    global_load_dwordx4 v[72:75], v1, s[50:51]
    v_add_u32 v1, 4096, v1
    global_load_dwordx4 v[76:79], v1, s[50:51]
    v_add_u32 v1, 4096, v1
    global_load_dwordx4 v[80:83], v1, s[50:51]
    v_add_u32 v1, 4096, v1
    global_load_dwordx4 v[84:87], v1, s[50:51]
    v_add_u32 v1, 4096, v1
    global_load_dwordx4 v[88:91], v1, s[50:51]
    v_add_u32 v1, 4096, v1
    v_mov_b32 v144, 0
    v_mov_b32 v145, 0
    v_mov_b32 v146, 0
    v_mov_b32 v147, 0
    s_and_b32 s32, s2, 7
    s_lshr_b32 s33, s2, 3
    s_lshl_b32 s32, s32, 3
    s_lshr_b32 s34, s33, 2
    s_add_u32 s32, s32, s34
    s_and_b32 s33, s33, 3
    s_lshl_b32 s34, s32, 18
    s_mul_i32 s35, s32, 393216
    s_mul_i32 s33, s33, 98304
    s_add_u32 s35, s35, s33
    v_lshrrev_b32 v14, 6, v0
    v_and_b32 v0, 63, v0
    v_readfirstlane_b32 s28, v14
    v_lshlrev_b32 v17, 4, v0
    s_mov_b32 s22, 0
    s_mov_b32 s23, 0
    s_lshl_b32 s47, s28, 13
    v_add_u32 v6, s47, v17
    v_add_u32 v3, 48, v6
    v_add_u32 v4, 32, v6
    v_add_u32 v5, 16, v6
    s_mul_i32 s24, s28, 8320
    s_add_u32 s25, s24, 66560
    s_mov_b32 s26, 33280
    s_mul_i32 s49, s28, 16384
    s_waitcnt lgkmcnt(0)
    s_add_u32 s8, s38, s34
    s_addc_u32 s9, s39, 0
    s_sub_u32 s8, s8, 48
    s_subb_u32 s9, s9, 0
    s_mov_b32 s10, 262192
    s_mov_b32 s11, 0x20000
    s_add_u32 s4, s36, s35
    s_addc_u32 s5, s37, 0
    s_sub_u32 s4, s4, 48
    s_subb_u32 s5, s5, 0
    s_mov_b32 s6, 98352
    s_mov_b32 s7, 0x20000
    s_mov_b32 m0, s24
    s_nop 0
    buffer_load_dwordx4 v3, s[8:11], s22 offen offset:0 lds
    buffer_load_dwordx4 v4, s[8:11], s22 offen offset:1040 lds
    buffer_load_dwordx4 v5, s[8:11], s22 offen offset:2080 lds
    buffer_load_dwordx4 v6, s[8:11], s22 offen offset:3120 lds
    s_add_u32 m0, s24, 4160
    s_add_u32 s22, s22, 4096
    buffer_load_dwordx4 v3, s[8:11], s22 offen offset:0 lds
    buffer_load_dwordx4 v4, s[8:11], s22 offen offset:1040 lds
    buffer_load_dwordx4 v5, s[8:11], s22 offen offset:2080 lds
    buffer_load_dwordx4 v6, s[8:11], s22 offen offset:3120 lds
    s_add_u32 s22, s22, 28672
    s_add_u32 s24, s24, s26
    s_mul_i32 m0, s28, 8320
    s_add_u32 m0, m0, 33280
    s_add_u32 s48, s49, 0
    buffer_load_dwordx4 v3, s[4:7], s48 offen offset:0 nt lds
    buffer_load_dwordx4 v4, s[4:7], s48 offen offset:1040 nt lds
    buffer_load_dwordx4 v5, s[4:7], s48 offen offset:2080 nt lds
    buffer_load_dwordx4 v6, s[4:7], s48 offen offset:3120 nt lds
    s_mul_i32 m0, s28, 8320
    s_add_u32 m0, m0, 37440
    s_add_u32 s48, s49, 4096
    buffer_load_dwordx4 v3, s[4:7], s48 offen offset:0 nt lds
    buffer_load_dwordx4 v4, s[4:7], s48 offen offset:1040 nt lds
    buffer_load_dwordx4 v5, s[4:7], s48 offen offset:2080 nt lds
    buffer_load_dwordx4 v6, s[4:7], s48 offen offset:3120 nt lds
    s_mul_i32 m0, s28, 8320
    s_add_u32 m0, m0, 66560
    s_add_u32 s48, s49, 8192
    buffer_load_dwordx4 v3, s[4:7], s48 offen offset:0 nt lds
    buffer_load_dwordx4 v4, s[4:7], s48 offen offset:1040 nt lds
    buffer_load_dwordx4 v5, s[4:7], s48 offen offset:2080 nt lds
    buffer_load_dwordx4 v6, s[4:7], s48 offen offset:3120 nt lds
    s_mul_i32 m0, s28, 8320
    s_add_u32 m0, m0, 70720
    s_add_u32 s48, s49, 12288
    buffer_load_dwordx4 v3, s[4:7], s48 offen offset:0 nt lds
    buffer_load_dwordx4 v4, s[4:7], s48 offen offset:1040 nt lds
    buffer_load_dwordx4 v5, s[4:7], s48 offen offset:2080 nt lds
    buffer_load_dwordx4 v6, s[4:7], s48 offen offset:3120 nt lds
    s_mul_i32 m0, s28, 8320
    s_add_u32 m0, m0, 99840
    s_add_u32 s48, s49, 16384
    buffer_load_dwordx4 v3, s[4:7], s48 offen offset:0 nt lds
    buffer_load_dwordx4 v4, s[4:7], s48 offen offset:1040 nt lds
    buffer_load_dwordx4 v5, s[4:7], s48 offen offset:2080 nt lds
    buffer_load_dwordx4 v6, s[4:7], s48 offen offset:3120 nt lds
    s_mul_i32 m0, s28, 8320
    s_add_u32 m0, m0, 104000
    s_add_u32 s48, s49, 20480
    buffer_load_dwordx4 v3, s[4:7], s48 offen offset:0 nt lds
    buffer_load_dwordx4 v4, s[4:7], s48 offen offset:1040 nt lds
    buffer_load_dwordx4 v5, s[4:7], s48 offen offset:2080 nt lds
    buffer_load_dwordx4 v6, s[4:7], s48 offen offset:3120 nt lds
    v_and_b32 v15, 15, v0
    v_and_b32 v14, 7, v15
    v_mfma_f32_32x32x16_bf16 v[192:207], v[144:147], v[144:147], 0
    v_mul_u32_u24 v14, 2080, v14
    v_lshrrev_b32 v16, 1, v15
    v_xor_b32 v16, v16, v15
    v_mfma_f32_32x32x16_bf16 v[208:223], v[144:147], v[144:147], 0
    v_bfe_u32 v16, v16, 2, 1
    v_lshl_add_u32 v14, v16, 9, v14
    v_lshrrev_b32 v15, 4, v0
    v_mfma_f32_32x32x16_bf16 v[224:239], v[144:147], v[144:147], 0
    v_lshl_add_u32 v1, v15, 4, v14
    v_lshrrev_b32 v15, 2, v0
    v_and_b32 v14, 7, v15
    v_mfma_f32_32x32x16_bf16 v[240:255], v[144:147], v[144:147], 0
    v_mul_u32_u24 v14, 2080, v14
    v_lshrrev_b32 v16, 1, v15
    v_xor_b32 v16, v16, v15
    v_mfma_f32_32x32x16_bf16 a[96:111], v[144:147], v[144:147], 0
    v_bfe_u32 v16, v16, 2, 1
    v_lshl_add_u32 v14, v16, 9, v14
    v_and_b32 v15, 3, v0
    v_mfma_f32_32x32x16_bf16 a[112:127], v[144:147], v[144:147], 0
    v_lshl_add_u32 v14, v15, 3, v14
    v_add_u32 v2, 66560, v14
    s_mov_b32 s29, 7
    v_mfma_f32_32x32x16_bf16 a[128:143], v[144:147], v[144:147], 0
    s_mov_b32 s20, 0x3db8aa3b
    s_mov_b32 s27, 0
    s_mov_b32 s21, 0
    v_mfma_f32_32x32x16_bf16 a[144:159], v[144:147], v[144:147], 0
    s_mov_b32 s47, 0x3f803f80
    v_mov_b32 v10, 1.0
    v_mov_b32 v11, 1.0
    v_mfma_f32_32x32x16_bf16 a[160:175], v[144:147], v[144:147], 0
    v_mov_b32 v12, 1.0
    v_mfma_f32_32x32x16_bf16 a[176:191], v[144:147], v[144:147], 0
    v_mfma_f32_32x32x16_bf16 a[192:207], v[144:147], v[144:147], 0
    v_mfma_f32_32x32x16_bf16 a[208:223], v[144:147], v[144:147], 0
    v_mfma_f32_32x32x16_bf16 a[224:239], v[144:147], v[144:147], 0
    s_nop 7
    s_nop 3
    v_accvgpr_write_b32 a236, s47
    v_accvgpr_write_b32 a237, s47
    v_accvgpr_write_b32 a238, s47
    v_accvgpr_write_b32 a239, s47
    s_add_u32 s12, s40, s34
    s_addc_u32 s13, s41, 0
    s_sub_u32 s12, s12, 48
    s_subb_u32 s13, s13, 0
    s_mov_b32 s14, 262192
    s_mov_b32 s15, 0x20000
    s_add_u32 s16, s42, s35
    s_addc_u32 s17, s43, 0
    s_mov_b32 s18, 98304
    s_mov_b32 s19, 0x20000
    v_bfe_u32 v14, v0, 1, 3
    v_mul_u32_u24 v14, 1040, v14
    v_and_b32 v15, 1, v0
    v_lshl_add_u32 v14, v15, 9, v14
    v_lshrrev_b32 v15, 4, v0
    v_lshl_add_u32 v14, v15, 4, v14
    s_mul_i32 s47, s28, 8320
    s_add_u32 s47, s47, 33280
    v_add_u32 v18, s47, v14
    v_add_u32 v19, 66560, v18
    s_waitcnt vmcnt(8)
    ds_read_b128 a[0:3], v18 offset:0
    ds_read_b128 a[32:35], v18 offset:33280
    ds_read_b128 a[4:7], v18 offset:64
    ds_read_b128 a[36:39], v18 offset:33344
    ds_read_b128 a[8:11], v18 offset:128
    ds_read_b128 a[40:43], v18 offset:33408
    ds_read_b128 a[12:15], v18 offset:192
    ds_read_b128 a[44:47], v18 offset:33472
    ds_read_b128 a[16:19], v18 offset:256
    ds_read_b128 a[48:51], v18 offset:33536
    ds_read_b128 a[20:23], v18 offset:320
    ds_read_b128 a[52:55], v18 offset:33600
    ds_read_b128 a[24:27], v18 offset:384
    ds_read_b128 a[56:59], v18 offset:33664
    ds_read_b128 a[28:31], v18 offset:448
    ds_read_b128 a[60:63], v18 offset:33728
    s_barrier
    ds_read_b128 v[144:147], v1 offset:0
    ds_read_b128 v[148:151], v1 offset:64
    ds_read_b128 v[152:155], v1 offset:128
    ds_read_b128 v[156:159], v1 offset:192
    s_waitcnt lgkmcnt(0)
    v_mfma_f32_16x16x32_bf16 v[24:27], v[144:147], a[0:3], 0
    ds_read_b128 v[160:163], v1 offset:256
    ds_read_b128 v[164:167], v1 offset:320
    ds_read_b128 v[168:171], v1 offset:384
    v_mfma_f32_16x16x32_bf16 v[24:27], v[148:151], a[4:7], v[24:27]
    ds_read_b128 v[172:175], v1 offset:448
    ds_read_b128 v[176:179], v1 offset:1040
    ds_read_b128 v[180:183], v1 offset:1104
    v_mfma_f32_16x16x32_bf16 v[24:27], v[152:155], a[8:11], v[24:27]
    ds_read_b128 v[184:187], v1 offset:1168
    ds_read_b128 v[188:191], v1 offset:1232
    ds_read_b128 a[240:243], v1 offset:1296
    v_mfma_f32_16x16x32_bf16 v[24:27], v[156:159], a[12:15], v[24:27]
    ds_read_b128 a[244:247], v1 offset:1360
    ds_read_b128 a[248:251], v1 offset:1424
    ds_read_b128 a[252:255], v1 offset:1488
    v_mfma_f32_16x16x32_bf16 v[40:43], v[144:147], a[32:35], 0
    v_mfma_f32_16x16x32_bf16 v[40:43], v[148:151], a[36:39], v[40:43]
    v_mfma_f32_16x16x32_bf16 v[40:43], v[152:155], a[40:43], v[40:43]
    v_mfma_f32_16x16x32_bf16 v[40:43], v[156:159], a[44:47], v[40:43]
    s_waitcnt lgkmcnt(8)
    v_mfma_f32_16x16x32_bf16 v[24:27], v[160:163], a[16:19], v[24:27]
    ds_read_b128 v[144:147], v1 offset:16640
    ds_read_b128 v[148:151], v1 offset:16704
    ds_read_b128 v[152:155], v1 offset:16768
    v_mfma_f32_16x16x32_bf16 v[24:27], v[164:167], a[20:23], v[24:27]
    ds_read_b128 v[156:159], v1 offset:16832
    s_mov_b32 m0, s24
    v_mfma_f32_16x16x32_bf16 v[24:27], v[168:171], a[24:27], v[24:27]
    v_mfma_f32_16x16x32_bf16 v[24:27], v[172:175], a[28:31], v[24:27]
    buffer_load_dwordx4 v3, s[8:11], s22 offen offset:0 lds
    v_mfma_f32_16x16x32_bf16 v[40:43], v[160:163], a[48:51], v[40:43]
    v_mfma_f32_16x16x32_bf16 v[40:43], v[164:167], a[52:55], v[40:43]
    v_mfma_f32_16x16x32_bf16 v[40:43], v[168:171], a[56:59], v[40:43]
    buffer_load_dwordx4 v4, s[8:11], s22 offen offset:1040 lds
    v_mfma_f32_16x16x32_bf16 v[40:43], v[172:175], a[60:63], v[40:43]
    s_waitcnt lgkmcnt(8)
    v_mfma_f32_16x16x32_bf16 v[28:31], v[176:179], a[0:3], 0
    ds_read_b128 v[160:163], v1 offset:16896
    ds_read_b128 v[164:167], v1 offset:16960
    ds_read_b128 v[168:171], v1 offset:17024
    v_mfma_f32_16x16x32_bf16 v[28:31], v[180:183], a[4:7], v[28:31]
    ds_read_b128 v[172:175], v1 offset:17088
    buffer_load_dwordx4 v5, s[8:11], s22 offen offset:2080 lds
    v_mfma_f32_16x16x32_bf16 v[28:31], v[184:187], a[8:11], v[28:31]
    v_mfma_f32_16x16x32_bf16 v[28:31], v[188:191], a[12:15], v[28:31]
    v_mfma_f32_16x16x32_bf16 v[44:47], v[176:179], a[32:35], 0
    buffer_load_dwordx4 v6, s[8:11], s22 offen offset:3120 lds
    v_mfma_f32_16x16x32_bf16 v[44:47], v[180:183], a[36:39], v[44:47]
    v_mfma_f32_16x16x32_bf16 v[44:47], v[184:187], a[40:43], v[44:47]
    v_mfma_f32_16x16x32_bf16 v[44:47], v[188:191], a[44:47], v[44:47]
    s_add_u32 m0, s24, 4160
    s_add_u32 s22, s22, 4096
    s_waitcnt lgkmcnt(8)
    v_mfma_f32_16x16x32_bf16 v[28:31], a[240:243], a[16:19], v[28:31]
    ds_read_b128 v[176:179], v1 offset:17680
    ds_read_b128 v[180:183], v1 offset:17744
    ds_read_b128 v[184:187], v1 offset:17808
    v_mfma_f32_16x16x32_bf16 v[28:31], a[244:247], a[20:23], v[28:31]
    ds_read_b128 v[188:191], v1 offset:17872
    v_mfma_f32_16x16x32_bf16 v[28:31], a[248:251], a[24:27], v[28:31]
    buffer_load_dwordx4 v3, s[8:11], s22 offen offset:0 lds
    v_mfma_f32_16x16x32_bf16 v[28:31], a[252:255], a[28:31], v[28:31]
    v_mfma_f32_16x16x32_bf16 v[44:47], a[240:243], a[48:51], v[44:47]
    v_mfma_f32_16x16x32_bf16 v[44:47], a[244:247], a[52:55], v[44:47]
    buffer_load_dwordx4 v4, s[8:11], s22 offen offset:1040 lds
    v_mfma_f32_16x16x32_bf16 v[44:47], a[248:251], a[56:59], v[44:47]
    v_mfma_f32_16x16x32_bf16 v[44:47], a[252:255], a[60:63], v[44:47]
    v_max3_f32 v14, v24, v25, v26
    s_nop 1
    v_max3_f32 v14, v14, v27, v28
    s_waitcnt lgkmcnt(8)
    v_mfma_f32_16x16x32_bf16 v[32:35], v[144:147], a[0:3], 0
    v_max3_f32 v14, v14, v29, v30
    v_max_f32 v14, v14, v31
    v_mov_b32 v15, v14
    v_mfma_f32_16x16x32_bf16 v[32:35], v[148:151], a[4:7], v[32:35]
    s_nop 1
    v_permlane32_swap_b32 v15, v14
    s_nop 0
    v_mfma_f32_16x16x32_bf16 v[32:35], v[152:155], a[8:11], v[32:35]
    v_max_f32 v14, v14, v15
    v_mov_b32 v15, v14
    s_nop 1
    v_mfma_f32_16x16x32_bf16 v[32:35], v[156:159], a[12:15], v[32:35]
    v_permlane16_swap_b32 v15, v14
    s_nop 0
    v_max_f32 v14, v14, v15
    v_mfma_f32_16x16x32_bf16 v[48:51], v[144:147], a[32:35], 0
    v_mul_f32 v7, 0xbdb8aa3b, v14
    v_fma_f32 v72, v24, s20, v7
    v_fma_f32 v73, v25, s20, v7
    v_mfma_f32_16x16x32_bf16 v[48:51], v[148:151], a[36:39], v[48:51]
    v_fma_f32 v74, v26, s20, v7
    v_fma_f32 v75, v27, s20, v7
    v_fma_f32 v76, v28, s20, v7
    v_mfma_f32_16x16x32_bf16 v[48:51], v[152:155], a[40:43], v[48:51]
    buffer_load_dwordx4 v5, s[8:11], s22 offen offset:2080 lds
    v_fma_f32 v77, v29, s20, v7
    v_mfma_f32_16x16x32_bf16 v[48:51], v[156:159], a[44:47], v[48:51]
    v_fma_f32 v78, v30, s20, v7
    v_fma_f32 v79, v31, s20, v7
    s_waitcnt lgkmcnt(4)
    v_mfma_f32_16x16x32_bf16 v[32:35], v[160:163], a[16:19], v[32:35]
    buffer_load_dwordx4 v6, s[8:11], s22 offen offset:3120 lds
    v_max3_f32 v14, v40, v41, v42
    v_mfma_f32_16x16x32_bf16 v[32:35], v[164:167], a[20:23], v[32:35]
    v_max3_f32 v14, v14, v43, v44
    v_max3_f32 v14, v14, v45, v46
    v_max_f32 v14, v14, v47
    v_mfma_f32_16x16x32_bf16 v[32:35], v[168:171], a[24:27], v[32:35]
    v_mov_b32 v15, v14
    s_nop 1
    v_permlane32_swap_b32 v15, v14
    v_mfma_f32_16x16x32_bf16 v[32:35], v[172:175], a[28:31], v[32:35]
    ds_read_b128 a[240:243], v1 offset:17936
    s_nop 0
    v_max_f32 v14, v14, v15
    v_mfma_f32_16x16x32_bf16 v[48:51], v[160:163], a[48:51], v[48:51]
    ds_read_b128 a[244:247], v1 offset:18000
    ds_read_b128 a[248:251], v1 offset:18064
    v_mov_b32 v15, v14
    v_mfma_f32_16x16x32_bf16 v[48:51], v[164:167], a[52:55], v[48:51]
    ds_read_b128 a[252:255], v1 offset:18128
    s_nop 1
    v_permlane16_swap_b32 v15, v14
    v_mfma_f32_16x16x32_bf16 v[48:51], v[168:171], a[56:59], v[48:51]
    s_nop 0
    v_max_f32 v14, v14, v15
    v_mul_f32 v8, 0xbdb8aa3b, v14
    v_mfma_f32_16x16x32_bf16 v[48:51], v[172:175], a[60:63], v[48:51]
    v_fma_f32 v88, v40, s20, v8
    v_fma_f32 v89, v41, s20, v8
    s_waitcnt lgkmcnt(4)
    v_mfma_f32_16x16x32_bf16 v[36:39], v[176:179], a[0:3], 0
    v_fma_f32 v90, v42, s20, v8
    v_fma_f32 v91, v43, s20, v8
    v_fma_f32 v92, v44, s20, v8
    v_mfma_f32_16x16x32_bf16 v[36:39], v[180:183], a[4:7], v[36:39]
    v_fma_f32 v93, v45, s20, v8
    v_fma_f32 v94, v46, s20, v8
    v_fma_f32 v95, v47, s20, v8
    v_mfma_f32_16x16x32_bf16 v[36:39], v[184:187], a[8:11], v[36:39]
    v_exp_f32 v72, v72
    v_mfma_f32_16x16x32_bf16 v[36:39], v[188:191], a[12:15], v[36:39]
    ds_read_b128 v[144:147], v1 offset:0
    v_exp_f32 v73, v73
    v_mfma_f32_16x16x32_bf16 v[52:55], v[176:179], a[32:35], 0
    ds_read_b128 v[148:151], v1 offset:64
    ds_read_b128 v[152:155], v1 offset:128
    ds_read_b128 v[156:159], v1 offset:192
    v_mfma_f32_16x16x32_bf16 v[52:55], v[180:183], a[36:39], v[52:55]
    v_exp_f32 v74, v74
    v_mfma_f32_16x16x32_bf16 v[52:55], v[184:187], a[40:43], v[52:55]
    v_exp_f32 v75, v75
    v_mfma_f32_16x16x32_bf16 v[52:55], v[188:191], a[44:47], v[52:55]
    ds_read_b128 v[160:163], v1 offset:256
    ds_read_b128 v[164:167], v1 offset:320
    s_waitcnt lgkmcnt(6)
    v_mfma_f32_16x16x32_bf16 v[36:39], a[240:243], a[16:19], v[36:39]
    ds_read_b128 v[168:171], v1 offset:384
    v_exp_f32 v88, v88
    v_mfma_f32_16x16x32_bf16 v[36:39], a[244:247], a[20:23], v[36:39]
    ds_read_b128 v[172:175], v1 offset:448
    v_exp_f32 v89, v89
    v_mfma_f32_16x16x32_bf16 v[36:39], a[248:251], a[24:27], v[36:39]
    s_add_u32 s22, s22, 28672
    s_sub_u32 s24, s24, s26
    v_fma_f32 v80, v32, s20, v7
    v_mfma_f32_16x16x32_bf16 v[36:39], a[252:255], a[28:31], v[36:39]
    ds_read_b128 v[176:179], v1 offset:1040
    v_fma_f32 v81, v33, s20, v7
    v_fma_f32 v82, v34, s20, v7
    v_mfma_f32_16x16x32_bf16 v[52:55], a[240:243], a[48:51], v[52:55]
    ds_read_b128 v[180:183], v1 offset:1104
    ds_read_b128 v[184:187], v1 offset:1168
    s_mov_b32 m0, s25
    v_mfma_f32_16x16x32_bf16 v[52:55], a[244:247], a[52:55], v[52:55]
    buffer_load_dwordx4 v3, s[12:15], s23 offen offset:0 lds
    buffer_load_dwordx4 v4, s[12:15], s23 offen offset:1040 lds
    buffer_load_dwordx4 v5, s[12:15], s23 offen offset:2080 lds
    buffer_load_dwordx4 v6, s[12:15], s23 offen offset:3120 lds
    s_add_u32 m0, s25, 4160
    s_add_u32 s23, s23, 4096
    s_waitcnt vmcnt(12)
    ds_read_b128 a[64:67], v19 offset:0
    ds_read_b128 a[68:71], v19 offset:64
    ds_read_b128 a[72:75], v19 offset:128
    ds_read_b128 a[76:79], v19 offset:192
    ds_read_b128 a[80:83], v19 offset:256
    ds_read_b128 a[84:87], v19 offset:320
    ds_read_b128 a[88:91], v19 offset:384
    ds_read_b128 a[92:95], v19 offset:448
    v_mfma_f32_16x16x32_bf16 v[52:55], a[248:251], a[56:59], v[52:55]
    ds_read_b128 v[188:191], v1 offset:1232
    v_exp_f32 v90, v90
    v_mfma_f32_16x16x32_bf16 v[52:55], a[252:255], a[60:63], v[52:55]
    ds_read_b128 a[240:243], v1 offset:1296
    v_fma_f32 v83, v35, s20, v7
    s_waitcnt lgkmcnt(9)
    v_mfma_f32_16x16x32_bf16 v[56:59], v[144:147], a[64:67], 0
    ds_read_b128 a[244:247], v1 offset:1360
    ds_read_b128 a[248:251], v1 offset:1424
    v_max3_f32 v13, v80, v81, v82
    s_waitcnt lgkmcnt(10)
    v_mfma_f32_16x16x32_bf16 v[56:59], v[148:151], a[68:71], v[56:59]
    ds_read_b128 a[252:255], v1 offset:1488
    v_max_f32 v13, v13, v83
    s_waitcnt lgkmcnt(10)
    v_mfma_f32_16x16x32_bf16 v[56:59], v[152:155], a[72:75], v[56:59]
    v_exp_f32 v91, v91
    v_fma_f32 v96, v48, s20, v8
    s_waitcnt lgkmcnt(9)
    v_mfma_f32_16x16x32_bf16 v[56:59], v[156:159], a[76:79], v[56:59]
    ds_read_b128 v[144:147], v1 offset:16640
    v_fma_f32 v97, v49, s20, v8
    s_waitcnt lgkmcnt(9)
    v_mfma_f32_16x16x32_bf16 v[56:59], v[160:163], a[80:83], v[56:59]
    ds_read_b128 v[148:151], v1 offset:16704
    ds_read_b128 v[152:155], v1 offset:16768
    v_fma_f32 v98, v50, s20, v8
    s_waitcnt lgkmcnt(10)
    v_mfma_f32_16x16x32_bf16 v[56:59], v[164:167], a[84:87], v[56:59]
    ds_read_b128 v[156:159], v1 offset:16832
    v_exp_f32 v76, v76
    s_waitcnt lgkmcnt(10)
    v_mfma_f32_16x16x32_bf16 v[56:59], v[168:171], a[88:91], v[56:59]
    v_fma_f32 v99, v51, s20, v8
    v_max3_f32 v13, v13, v96, v97
    v_max3_f32 v13, v13, v98, v99
    s_waitcnt lgkmcnt(9)
    v_mfma_f32_16x16x32_bf16 v[56:59], v[172:175], a[92:95], v[56:59]
    ds_read_b128 v[160:163], v1 offset:16896
    ds_read_b128 v[164:167], v1 offset:16960
    s_waitcnt lgkmcnt(10)
    v_mfma_f32_16x16x32_bf16 v[60:63], v[176:179], a[64:67], 0
    ds_read_b128 v[168:171], v1 offset:17024
    v_exp_f32 v77, v77
    v_mfma_f32_16x16x32_bf16 v[60:63], v[180:183], a[68:71], v[60:63]
    ds_read_b128 v[172:175], v1 offset:17088
    v_exp_f32 v78, v78
    v_mfma_f32_16x16x32_bf16 v[60:63], v[184:187], a[72:75], v[60:63]
    v_exp_f32 v79, v79
    v_mfma_f32_16x16x32_bf16 v[60:63], v[188:191], a[76:79], v[60:63]
    ds_read_b128 v[176:179], v1 offset:17680
    ds_read_b128 v[180:183], v1 offset:17744
    s_waitcnt lgkmcnt(10)
    v_mfma_f32_16x16x32_bf16 v[60:63], a[240:243], a[80:83], v[60:63]
    buffer_load_dwordx4 v3, s[12:15], s23 offen offset:0 lds
    ds_read_b128 v[184:187], v1 offset:17808
    v_mfma_f32_16x16x32_bf16 v[60:63], a[244:247], a[84:87], v[60:63]
    buffer_load_dwordx4 v4, s[12:15], s23 offen offset:1040 lds
    ds_read_b128 v[188:191], v1 offset:17872
    v_mfma_f32_16x16x32_bf16 v[60:63], a[248:251], a[88:91], v[60:63]
    buffer_load_dwordx4 v5, s[12:15], s23 offen offset:2080 lds
    ds_read_b128 a[240:243], v1 offset:17936
    v_mfma_f32_16x16x32_bf16 v[60:63], a[252:255], a[92:95], v[60:63]
    buffer_load_dwordx4 v6, s[12:15], s23 offen offset:3120 lds
    s_waitcnt lgkmcnt(9)
    v_mfma_f32_16x16x32_bf16 v[64:67], v[144:147], a[64:67], 0
    ds_read_b128 a[244:247], v1 offset:18000
    ds_read_b128 a[248:251], v1 offset:18064
    ds_read_b128 a[252:255], v1 offset:18128
    v_mfma_f32_16x16x32_bf16 v[64:67], v[148:151], a[68:71], v[64:67]
    v_exp_f32 v92, v92
    v_mfma_f32_16x16x32_bf16 v[64:67], v[152:155], a[72:75], v[64:67]
    v_exp_f32 v93, v93
    v_mfma_f32_16x16x32_bf16 v[64:67], v[156:159], a[76:79], v[64:67]
    v_exp_f32 v94, v94
    s_waitcnt lgkmcnt(8)
    v_mfma_f32_16x16x32_bf16 v[64:67], v[160:163], a[80:83], v[64:67]
    v_exp_f32 v95, v95
    v_fma_f32 v84, v36, s20, v7
    v_mfma_f32_16x16x32_bf16 v[64:67], v[164:167], a[84:87], v[64:67]
    v_fma_f32 v85, v37, s20, v7
    v_fma_f32 v86, v38, s20, v7
    v_fma_f32 v87, v39, s20, v7
    v_mfma_f32_16x16x32_bf16 v[64:67], v[168:171], a[88:91], v[64:67]
    v_max3_f32 v13, v13, v84, v85
    v_max3_f32 v13, v13, v86, v87
    v_fma_f32 v100, v52, s20, v8
    v_mfma_f32_16x16x32_bf16 v[64:67], v[172:175], a[92:95], v[64:67]
    s_add_u32 s23, s23, 28672
    s_add_u32 s25, s25, s26
    s_waitcnt lgkmcnt(4)
    v_mfma_f32_16x16x32_bf16 v[68:71], v[176:179], a[64:67], 0
    v_fma_f32 v101, v53, s20, v8
    v_fma_f32 v102, v54, s20, v8
    v_fma_f32 v103, v55, s20, v8
    v_mfma_f32_16x16x32_bf16 v[68:71], v[180:183], a[68:71], v[68:71]
    v_max3_f32 v13, v13, v100, v101
    v_max3_f32 v13, v13, v102, v103
    v_max3_f32 v21, v56, v57, v58
    v_mfma_f32_16x16x32_bf16 v[68:71], v[184:187], a[72:75], v[68:71]
    s_waitcnt lgkmcnt(0)
    s_barrier
    v_add_u32 v1, s26, v1
    v_mfma_f32_16x16x32_bf16 v[68:71], v[188:191], a[76:79], v[68:71]
    v_max3_f32 v21, v21, v59, v60
    v_max3_f32 v21, v21, v61, v62
    v_mfma_f32_16x16x32_bf16 v[68:71], a[240:243], a[80:83], v[68:71]
    v_cmp_lt_f32 vcc, 0x41000000, v13
    s_cbranch_vccnz L_rare1_p0
L_back1_p0:
    v_mfma_f32_16x16x32_bf16 v[68:71], a[244:247], a[84:87], v[68:71]
    v_exp_f32 v80, v80
    v_max_f32 v21, v21, v63
    v_mfma_f32_16x16x32_bf16 v[68:71], a[248:251], a[88:91], v[68:71]
    v_exp_f32 v81, v81
    v_mov_b32 v22, v21
    v_mfma_f32_16x16x32_bf16 v[68:71], a[252:255], a[92:95], v[68:71]
    v_exp_f32 v82, v82
    v_exp_f32 v83, v83
    v_exp_f32 v96, v96
    v_exp_f32 v97, v97
    v_exp_f32 v98, v98
    s_nop 1
    v_permlane32_swap_b32 v22, v21
    s_nop 0
    v_max_f32 v21, v21, v22
    v_mov_b32 v22, v21
    s_nop 1
    v_permlane16_swap_b32 v22, v21
    s_nop 0
    v_max_f32 v21, v21, v22
    v_mul_f32 v9, 0xbdb8aa3b, v21
    v_fma_f32 v104, v56, s20, v9
    v_fma_f32 v105, v57, s20, v9
    v_fma_f32 v106, v58, s20, v9
    v_fma_f32 v107, v59, s20, v9
    v_fma_f32 v108, v60, s20, v9
    v_fma_f32 v109, v61, s20, v9
    v_fma_f32 v110, v62, s20, v9
    v_fma_f32 v111, v63, s20, v9
    v_exp_f32 v104, v104
    v_exp_f32 v105, v105
    v_exp_f32 v106, v106
    v_exp_f32 v99, v99
    v_exp_f32 v84, v84
    v_exp_f32 v85, v85
    v_exp_f32 v86, v86
    v_exp_f32 v87, v87
    s_mov_b32 m0, s24
    s_nop 0
    buffer_load_dwordx4 v3, s[8:11], s22 offen offset:0 lds
    buffer_load_dwordx4 v4, s[8:11], s22 offen offset:1040 lds
    buffer_load_dwordx4 v5, s[8:11], s22 offen offset:2080 lds
    buffer_load_dwordx4 v6, s[8:11], s22 offen offset:3120 lds
    v_exp_f32 v100, v100
    v_fma_f32 v112, v64, s20, v9
    v_fma_f32 v113, v65, s20, v9
    v_fma_f32 v114, v66, s20, v9
    v_exp_f32 v107, v107
    v_fma_f32 v115, v67, s20, v9
    v_max3_f32 v16, v112, v113, v114
    v_max_f32 v16, v16, v115
    v_exp_f32 v108, v108
    v_exp_f32 v109, v109
    v_exp_f32 v110, v110
    v_exp_f32 v111, v111
    s_add_u32 m0, s24, 4160
    s_add_u32 s22, s22, 4096
    buffer_load_dwordx4 v3, s[8:11], s22 offen offset:0 lds
    buffer_load_dwordx4 v4, s[8:11], s22 offen offset:1040 lds
    buffer_load_dwordx4 v5, s[8:11], s22 offen offset:2080 lds
    buffer_load_dwordx4 v6, s[8:11], s22 offen offset:3120 lds
    v_exp_f32 v101, v101
    v_exp_f32 v102, v102
    s_add_u32 s22, s22, 28672
    s_add_u32 s24, s24, s26
    v_exp_f32 v103, v103
    v_fma_f32 v116, v68, s20, v9
    v_fma_f32 v117, v69, s20, v9
    v_fma_f32 v118, v70, s20, v9
    v_fma_f32 v119, v71, s20, v9
    v_max3_f32 v16, v16, v116, v117
    v_max3_f32 v16, v16, v118, v119
    v_cmp_lt_f32 vcc, 0x41000000, v16
    s_cbranch_vccnz L_rare1_p1
L_back1_p1:
    s_waitcnt vmcnt(16) lgkmcnt(0)
    s_barrier
    ds_read_b128 v[144:147], v1 offset:0
    ds_read_b128 v[148:151], v1 offset:64
    ds_read_b128 v[152:155], v1 offset:128
    ds_read_b128 v[156:159], v1 offset:192
    v_exp_f32 v112, v112
    v_exp_f32 v113, v113
    v_exp_f32 v114, v114
    v_exp_f32 v115, v115
    v_exp_f32 v116, v116
    v_exp_f32 v117, v117
    v_exp_f32 v118, v118
    v_exp_f32 v119, v119
    s_mov_b32 s27, 0
    v_mov_b32 v10, 1.0
    v_mov_b32 v11, 1.0
    v_mov_b32 v12, 1.0
    s_sub_u32 s26, 0, s26
    s_mov_b32 s21, 0
L_loop_l:
    s_waitcnt lgkmcnt(0)
    v_mfma_f32_16x16x32_bf16 v[24:27], v[144:147], a[0:3], 0
    ds_read_b128 v[160:163], v1 offset:256
    ds_read_b128 v[164:167], v1 offset:320
    v_mfma_f32_16x16x32_bf16 v[24:27], v[148:151], a[4:7], v[24:27]
    ds_read_b128 v[168:171], v1 offset:384
    ds_read_b128 v[172:175], v1 offset:448
    v_mfma_f32_16x16x32_bf16 v[24:27], v[152:155], a[8:11], v[24:27]
    ds_read_b128 v[176:179], v1 offset:1040
    ds_read_b128 v[180:183], v1 offset:1104
    v_mfma_f32_16x16x32_bf16 v[24:27], v[156:159], a[12:15], v[24:27]
    ds_read_b128 v[184:187], v1 offset:1168
    v_cvt_pk_bf16_f32 v120, v72, v73
    v_mfma_f32_16x16x32_bf16 v[40:43], v[144:147], a[32:35], 0
    ds_read_b128 v[188:191], v1 offset:1232
    v_cvt_pk_bf16_f32 v121, v74, v75
    v_mfma_f32_16x16x32_bf16 v[40:43], v[148:151], a[36:39], v[40:43]
    v_cvt_pk_bf16_f32 v122, v76, v77
    v_cvt_pk_bf16_f32 v123, v78, v79
    v_mfma_f32_16x16x32_bf16 v[40:43], v[152:155], a[40:43], v[40:43]
    v_cvt_pk_bf16_f32 v128, v88, v89
    v_cvt_pk_bf16_f32 v129, v90, v91
    v_mfma_f32_16x16x32_bf16 v[40:43], v[156:159], a[44:47], v[40:43]
    v_cvt_pk_bf16_f32 v130, v92, v93
    v_cvt_pk_bf16_f32 v131, v94, v95
    v_mfma_f32_16x16x32_bf16 v[56:59], v[144:147], a[64:67], 0
    v_cvt_pk_bf16_f32 v136, v104, v105
    v_cvt_pk_bf16_f32 v137, v106, v107
    v_mfma_f32_16x16x32_bf16 v[56:59], v[148:151], a[68:71], v[56:59]
    v_cvt_pk_bf16_f32 v138, v108, v109
    v_cvt_pk_bf16_f32 v139, v110, v111
    v_mfma_f32_16x16x32_bf16 v[56:59], v[152:155], a[72:75], v[56:59]
    ds_read_b128 a[240:243], v1 offset:1296
    ds_read_b128 a[244:247], v1 offset:1360
    v_mfma_f32_16x16x32_bf16 v[56:59], v[156:159], a[76:79], v[56:59]
    ds_read_b128 a[248:251], v1 offset:1424
    s_waitcnt lgkmcnt(7)
    v_mfma_f32_16x16x32_bf16 v[24:27], v[160:163], a[16:19], v[24:27]
    ds_read_b128 a[252:255], v1 offset:1488
    s_mov_b32 m0, s25
    v_mfma_f32_16x16x32_bf16 v[24:27], v[164:167], a[20:23], v[24:27]
    v_cvt_pk_bf16_f32 v124, v80, v81
    v_cvt_pk_bf16_f32 v125, v82, v83
    v_mfma_f32_16x16x32_bf16 v[24:27], v[168:171], a[24:27], v[24:27]
    v_cvt_pk_bf16_f32 v126, v84, v85
    v_cvt_pk_bf16_f32 v127, v86, v87
    v_mfma_f32_16x16x32_bf16 v[24:27], v[172:175], a[28:31], v[24:27]
    buffer_load_dwordx4 v3, s[12:15], s23 offen offset:0 lds
    v_mfma_f32_16x16x32_bf16 v[40:43], v[160:163], a[48:51], v[40:43]
    v_cvt_pk_bf16_f32 v132, v96, v97
    v_cvt_pk_bf16_f32 v133, v98, v99
    v_mfma_f32_16x16x32_bf16 v[40:43], v[164:167], a[52:55], v[40:43]
    v_cvt_pk_bf16_f32 v134, v100, v101
    v_cvt_pk_bf16_f32 v135, v102, v103
    v_mfma_f32_16x16x32_bf16 v[40:43], v[168:171], a[56:59], v[40:43]
    v_cvt_pk_bf16_f32 v140, v112, v113
    v_cvt_pk_bf16_f32 v141, v114, v115
    v_mfma_f32_16x16x32_bf16 v[40:43], v[172:175], a[60:63], v[40:43]
    v_cvt_pk_bf16_f32 v142, v116, v117
    v_cvt_pk_bf16_f32 v143, v118, v119
    v_mfma_f32_16x16x32_bf16 v[56:59], v[160:163], a[80:83], v[56:59]
    ds_read_b128 v[144:147], v1 offset:16640
    ds_read_b128 v[148:151], v1 offset:16704
    v_mfma_f32_16x16x32_bf16 v[56:59], v[164:167], a[84:87], v[56:59]
    ds_read_b128 v[152:155], v1 offset:16768
    ds_read_b128 v[156:159], v1 offset:16832
    v_mfma_f32_16x16x32_bf16 v[56:59], v[168:171], a[88:91], v[56:59]
    buffer_load_dwordx4 v4, s[12:15], s23 offen offset:1040 lds
    v_mfma_f32_16x16x32_bf16 v[56:59], v[172:175], a[92:95], v[56:59]
    v_fma_f32 v72, v24, s20, v7
    s_waitcnt lgkmcnt(8)
    v_mfma_f32_16x16x32_bf16 v[28:31], v[176:179], a[0:3], 0
    v_fma_f32 v73, v25, s20, v7
    v_fma_f32 v74, v26, s20, v7
    v_mfma_f32_16x16x32_bf16 v[28:31], v[180:183], a[4:7], v[28:31]
    v_fma_f32 v75, v27, s20, v7
    v_max3_f32 v13, v72, v73, v74
    v_mfma_f32_16x16x32_bf16 v[28:31], v[184:187], a[8:11], v[28:31]
    buffer_load_dwordx4 v5, s[12:15], s23 offen offset:2080 lds
    v_mfma_f32_16x16x32_bf16 v[28:31], v[188:191], a[12:15], v[28:31]
    v_max_f32 v13, v13, v75
    v_fma_f32 v88, v40, s20, v8
    v_mfma_f32_16x16x32_bf16 v[44:47], v[176:179], a[32:35], 0
    v_fma_f32 v89, v41, s20, v8
    v_fma_f32 v90, v42, s20, v8
    v_mfma_f32_16x16x32_bf16 v[44:47], v[180:183], a[36:39], v[44:47]
    v_fma_f32 v91, v43, s20, v8
    v_max3_f32 v13, v13, v88, v89
    v_mfma_f32_16x16x32_bf16 v[44:47], v[184:187], a[40:43], v[44:47]
    v_max3_f32 v13, v13, v90, v91
    v_fma_f32 v104, v56, s20, v9
    v_mfma_f32_16x16x32_bf16 v[44:47], v[188:191], a[44:47], v[44:47]
    buffer_load_dwordx4 v6, s[12:15], s23 offen offset:3120 lds
    v_mfma_f32_16x16x32_bf16 v[60:63], v[176:179], a[64:67], 0
    ds_read_b128 v[160:163], v1 offset:16896
    ds_read_b128 v[164:167], v1 offset:16960
    v_mfma_f32_16x16x32_bf16 v[60:63], v[180:183], a[68:71], v[60:63]
    ds_read_b128 v[168:171], v1 offset:17024
    ds_read_b128 v[172:175], v1 offset:17088
    v_mfma_f32_16x16x32_bf16 v[60:63], v[184:187], a[72:75], v[60:63]
    v_fma_f32 v105, v57, s20, v9
    v_fma_f32 v106, v58, s20, v9
    v_mfma_f32_16x16x32_bf16 v[60:63], v[188:191], a[76:79], v[60:63]
    v_fma_f32 v107, v59, s20, v9
    s_waitcnt lgkmcnt(8)
    v_mfma_f32_16x16x32_bf16 v[28:31], a[240:243], a[16:19], v[28:31]
    v_max3_f32 v13, v13, v104, v105
    v_max3_f32 v13, v13, v106, v107
    v_mfma_f32_16x16x32_bf16 v[28:31], a[244:247], a[20:23], v[28:31]
    s_add_u32 m0, s25, 4160
    s_add_u32 s23, s23, 4096
    v_mfma_f32_16x16x32_bf16 v[28:31], a[248:251], a[24:27], v[28:31]
    v_mfma_f32_16x16x32_bf16 v[28:31], a[252:255], a[28:31], v[28:31]
    v_mfma_f32_16x16x32_bf16 v[44:47], a[240:243], a[48:51], v[44:47]
    v_mfma_f32_16x16x32_bf16 v[44:47], a[244:247], a[52:55], v[44:47]
    v_mfma_f32_16x16x32_bf16 v[44:47], a[248:251], a[56:59], v[44:47]
    buffer_load_dwordx4 v3, s[12:15], s23 offen offset:0 lds
    v_mfma_f32_16x16x32_bf16 v[44:47], a[252:255], a[60:63], v[44:47]
    s_nop 2
    v_fma_f32 v76, v28, s20, v7
    v_fma_f32 v77, v29, s20, v7
    v_mfma_f32_16x16x32_bf16 v[60:63], a[240:243], a[80:83], v[60:63]
    ds_read_b128 v[176:179], v1 offset:17680
    ds_read_b128 v[180:183], v1 offset:17744
    v_mfma_f32_16x16x32_bf16 v[60:63], a[244:247], a[84:87], v[60:63]
    ds_read_b128 v[184:187], v1 offset:17808
    ds_read_b128 v[188:191], v1 offset:17872
    v_mfma_f32_16x16x32_bf16 v[60:63], a[248:251], a[88:91], v[60:63]
    v_fma_f32 v78, v30, s20, v7
    v_fma_f32 v79, v31, s20, v7
    v_mfma_f32_16x16x32_bf16 v[60:63], a[252:255], a[92:95], v[60:63]
    v_max3_f32 v13, v13, v76, v77
    s_waitcnt lgkmcnt(8)
    v_mfma_f32_16x16x32_bf16 v[32:35], v[144:147], a[0:3], 0
    buffer_load_dwordx4 v4, s[12:15], s23 offen offset:1040 lds
    v_mfma_f32_16x16x32_bf16 v[32:35], v[148:151], a[4:7], v[32:35]
    v_max3_f32 v13, v13, v78, v79
    v_fma_f32 v92, v44, s20, v8
    v_mfma_f32_16x16x32_bf16 v[32:35], v[152:155], a[8:11], v[32:35]
    v_fma_f32 v93, v45, s20, v8
    v_fma_f32 v94, v46, s20, v8
    v_mfma_f32_16x16x32_bf16 v[32:35], v[156:159], a[12:15], v[32:35]
    v_fma_f32 v95, v47, s20, v8
    v_max3_f32 v13, v13, v92, v93
    v_mfma_f32_16x16x32_bf16 v[48:51], v[144:147], a[32:35], 0
    v_max3_f32 v13, v13, v94, v95
    v_fma_f32 v108, v60, s20, v9
    v_mfma_f32_16x16x32_bf16 v[48:51], v[148:151], a[36:39], v[48:51]
    buffer_load_dwordx4 v5, s[12:15], s23 offen offset:2080 lds
    v_mfma_f32_16x16x32_bf16 v[48:51], v[152:155], a[40:43], v[48:51]
    v_fma_f32 v109, v61, s20, v9
    v_fma_f32 v110, v62, s20, v9
    v_mfma_f32_16x16x32_bf16 v[48:51], v[156:159], a[44:47], v[48:51]
    v_fma_f32 v111, v63, s20, v9
    v_max3_f32 v13, v13, v108, v109
    v_mfma_f32_16x16x32_bf16 v[64:67], v[144:147], a[64:67], 0
    ds_read_b128 a[240:243], v1 offset:17936
    ds_read_b128 a[244:247], v1 offset:18000
    v_mfma_f32_16x16x32_bf16 v[64:67], v[148:151], a[68:71], v[64:67]
    ds_read_b128 a[248:251], v1 offset:18064
    ds_read_b128 a[252:255], v1 offset:18128
    v_mfma_f32_16x16x32_bf16 v[64:67], v[152:155], a[72:75], v[64:67]
    v_max3_f32 v13, v13, v110, v111
    v_cmp_lt_f32 vcc, 0x41000000, v13
    v_mfma_f32_16x16x32_bf16 v[64:67], v[156:159], a[76:79], v[64:67]
    s_waitcnt lgkmcnt(8)
    v_mfma_f32_16x16x32_bf16 v[32:35], v[160:163], a[16:19], v[32:35]
    buffer_load_dwordx4 v6, s[12:15], s23 offen offset:3120 lds
    v_mfma_f32_16x16x32_bf16 v[32:35], v[164:167], a[20:23], v[32:35]
    s_cbranch_vccnz L_rare0_l0
L_back0_l0:
    v_mfma_f32_16x16x32_bf16 v[32:35], v[168:171], a[24:27], v[32:35]
    v_exp_f32 v72, v72
    v_mfma_f32_16x16x32_bf16 v[32:35], v[172:175], a[28:31], v[32:35]
    v_exp_f32 v73, v73
    v_mfma_f32_16x16x32_bf16 v[48:51], v[160:163], a[48:51], v[48:51]
    s_add_u32 s23, s23, 28672
    s_add_u32 s25, s25, s26
    v_mfma_f32_16x16x32_bf16 v[48:51], v[164:167], a[52:55], v[48:51]
    v_exp_f32 v74, v74
    v_mfma_f32_16x16x32_bf16 v[48:51], v[168:171], a[56:59], v[48:51]
    v_exp_f32 v75, v75
    v_mfma_f32_16x16x32_bf16 v[48:51], v[172:175], a[60:63], v[48:51]
    v_exp_f32 v88, v88
    v_mfma_f32_16x16x32_bf16 v[64:67], v[160:163], a[80:83], v[64:67]
    v_exp_f32 v89, v89
    v_mfma_f32_16x16x32_bf16 v[64:67], v[164:167], a[84:87], v[64:67]
    v_exp_f32 v90, v90
    v_mfma_f32_16x16x32_bf16 v[64:67], v[168:171], a[88:91], v[64:67]
    v_exp_f32 v91, v91
    v_mfma_f32_16x16x32_bf16 v[64:67], v[172:175], a[92:95], v[64:67]
    s_waitcnt lgkmcnt(4)
    v_mfma_f32_16x16x32_bf16 v[36:39], v[176:179], a[0:3], 0
    v_exp_f32 v104, v104
    v_mfma_f32_16x16x32_bf16 v[36:39], v[180:183], a[4:7], v[36:39]
    v_fma_f32 v80, v32, s20, v7
    v_fma_f32 v81, v33, s20, v7
    v_mfma_f32_16x16x32_bf16 v[36:39], v[184:187], a[8:11], v[36:39]
    v_fma_f32 v82, v34, s20, v7
    v_mfma_f32_16x16x32_bf16 v[36:39], v[188:191], a[12:15], v[36:39]
    v_exp_f32 v105, v105
    v_mfma_f32_16x16x32_bf16 v[52:55], v[176:179], a[32:35], 0
    v_fma_f32 v83, v35, s20, v7
    v_max3_f32 v13, v80, v81, v82
    v_mfma_f32_16x16x32_bf16 v[52:55], v[180:183], a[36:39], v[52:55]
    v_max_f32 v13, v13, v83
    v_mfma_f32_16x16x32_bf16 v[52:55], v[184:187], a[40:43], v[52:55]
    v_exp_f32 v106, v106
    v_mfma_f32_16x16x32_bf16 v[52:55], v[188:191], a[44:47], v[52:55]
    v_fma_f32 v96, v48, s20, v8
    v_fma_f32 v97, v49, s20, v8
    v_mfma_f32_16x16x32_bf16 v[68:71], v[176:179], a[64:67], 0
    s_waitcnt vmcnt(16) lgkmcnt(0)
    s_barrier
    v_add_u32 v1, s26, v1
    v_mfma_f32_16x16x32_bf16 v[68:71], v[180:183], a[68:71], v[68:71]
    ds_read_b64_tr_b16 v[144:145], v2 offset:0
    ds_read_b64_tr_b16 v[146:147], v2 offset:1040
    v_mfma_f32_16x16x32_bf16 v[68:71], v[184:187], a[72:75], v[68:71]
    ds_read_b64_tr_b16 v[148:149], v2 offset:16640
    ds_read_b64_tr_b16 v[150:151], v2 offset:17680
    v_mfma_f32_16x16x32_bf16 v[68:71], v[188:191], a[76:79], v[68:71]
    ds_read_b64_tr_b16 v[152:153], v2 offset:32
    v_mfma_f32_16x16x32_bf16 v[36:39], a[240:243], a[16:19], v[36:39]
    ds_read_b64_tr_b16 v[154:155], v2 offset:1072
    ds_read_b64_tr_b16 v[156:157], v2 offset:16672
    v_mfma_f32_16x16x32_bf16 v[36:39], a[244:247], a[20:23], v[36:39]
    ds_read_b64_tr_b16 v[158:159], v2 offset:17712
    v_fma_f32 v98, v50, s20, v8
    v_mfma_f32_16x16x32_bf16 v[36:39], a[248:251], a[24:27], v[36:39]
    ds_read_b64_tr_b16 v[160:161], v2 offset:64
    ds_read_b64_tr_b16 v[162:163], v2 offset:1104
    v_mfma_f32_16x16x32_bf16 v[36:39], a[252:255], a[28:31], v[36:39]
    ds_read_b64_tr_b16 v[164:165], v2 offset:16704
    ds_read_b64_tr_b16 v[166:167], v2 offset:17744
    v_mfma_f32_16x16x32_bf16 v[52:55], a[240:243], a[48:51], v[52:55]
    ds_read_b64_tr_b16 v[168:169], v2 offset:96
    ds_read_b64_tr_b16 v[170:171], v2 offset:1136
    v_mfma_f32_16x16x32_bf16 v[52:55], a[244:247], a[52:55], v[52:55]
    ds_read_b64_tr_b16 v[172:173], v2 offset:16736
    ds_read_b64_tr_b16 v[174:175], v2 offset:17776
    v_mfma_f32_16x16x32_bf16 v[52:55], a[248:251], a[56:59], v[52:55]
    v_exp_f32 v107, v107
    v_mfma_f32_16x16x32_bf16 v[52:55], a[252:255], a[60:63], v[52:55]
    v_fma_f32 v99, v51, s20, v8
    v_max3_f32 v13, v13, v96, v97
    v_mfma_f32_16x16x32_bf16 v[68:71], a[240:243], a[80:83], v[68:71]
    v_max3_f32 v13, v13, v98, v99
    s_mov_b32 m0, s24
    v_mfma_f32_16x16x32_bf16 v[68:71], a[244:247], a[84:87], v[68:71]
    v_exp_f32 v76, v76
    v_mfma_f32_16x16x32_bf16 v[68:71], a[248:251], a[88:91], v[68:71]
    v_fma_f32 v112, v64, s20, v9
    v_fma_f32 v113, v65, s20, v9
    v_mfma_f32_16x16x32_bf16 v[68:71], a[252:255], a[92:95], v[68:71]
    v_fma_f32 v114, v66, s20, v9
    v_mfma_f32_16x16x32_bf16 a[224:227], a[236:239], v[120:123], a[224:227]
    v_exp_f32 v77, v77
    v_mfma_f32_16x16x32_bf16 a[224:227], a[236:239], v[124:127], a[224:227]
    v_fma_f32 v115, v67, s20, v9
    v_max3_f32 v13, v13, v112, v113
    v_mfma_f32_16x16x32_bf16 a[228:231], a[236:239], v[128:131], a[228:231]
    ds_read_b64_tr_b16 v[176:177], v2 offset:128
    ds_read_b64_tr_b16 v[178:179], v2 offset:1168
    v_mfma_f32_16x16x32_bf16 a[228:231], a[236:239], v[132:135], a[228:231]
    ds_read_b64_tr_b16 v[180:181], v2 offset:16768
    ds_read_b64_tr_b16 v[182:183], v2 offset:17808
    v_mfma_f32_16x16x32_bf16 a[232:235], a[236:239], v[136:139], a[232:235]
    ds_read_b64_tr_b16 v[184:185], v2 offset:160
    ds_read_b64_tr_b16 v[186:187], v2 offset:1200
    v_mfma_f32_16x16x32_bf16 a[232:235], a[236:239], v[140:143], a[232:235]
    ds_read_b64_tr_b16 v[188:189], v2 offset:16800
    s_waitcnt lgkmcnt(15)
    v_mfma_f32_16x16x32_bf16 v[192:195], v[144:147], v[120:123], v[192:195]
    ds_read_b64_tr_b16 v[190:191], v2 offset:17840
    v_max3_f32 v13, v13, v114, v115
    v_mfma_f32_16x16x32_bf16 v[192:195], v[148:151], v[124:127], v[192:195]
    v_exp_f32 v78, v78
    v_mfma_f32_16x16x32_bf16 a[96:99], v[144:147], v[128:131], a[96:99]
    buffer_load_dwordx4 v3, s[8:11], s22 offen offset:0 lds
    v_mfma_f32_16x16x32_bf16 a[96:99], v[148:151], v[132:135], a[96:99]
    v_exp_f32 v79, v79
    v_mfma_f32_16x16x32_bf16 a[160:163], v[144:147], v[136:139], a[160:163]
    v_exp_f32 v92, v92
    v_mfma_f32_16x16x32_bf16 a[160:163], v[148:151], v[140:143], a[160:163]
    buffer_load_dwordx4 v4, s[8:11], s22 offen offset:1040 lds
    v_mfma_f32_16x16x32_bf16 v[196:199], v[152:155], v[120:123], v[196:199]
    v_exp_f32 v93, v93
    v_mfma_f32_16x16x32_bf16 v[196:199], v[156:159], v[124:127], v[196:199]
    buffer_load_dwordx4 v5, s[8:11], s22 offen offset:2080 lds
    v_mfma_f32_16x16x32_bf16 a[100:103], v[152:155], v[128:131], a[100:103]
    ds_read_b64_tr_b16 a[240:241], v2 offset:192
    ds_read_b64_tr_b16 a[242:243], v2 offset:1232
    v_mfma_f32_16x16x32_bf16 a[100:103], v[156:159], v[132:135], a[100:103]
    ds_read_b64_tr_b16 a[244:245], v2 offset:16832
    ds_read_b64_tr_b16 a[246:247], v2 offset:17872
    v_mfma_f32_16x16x32_bf16 a[164:167], v[152:155], v[136:139], a[164:167]
    ds_read_b64_tr_b16 a[248:249], v2 offset:224
    ds_read_b64_tr_b16 a[250:251], v2 offset:1264
    v_mfma_f32_16x16x32_bf16 a[164:167], v[156:159], v[140:143], a[164:167]
    ds_read_b64_tr_b16 a[252:253], v2 offset:16864
    s_waitcnt lgkmcnt(15)
    v_mfma_f32_16x16x32_bf16 v[200:203], v[160:163], v[120:123], v[200:203]
    ds_read_b64_tr_b16 a[254:255], v2 offset:17904
    v_mfma_f32_16x16x32_bf16 v[200:203], v[164:167], v[124:127], v[200:203]
    buffer_load_dwordx4 v6, s[8:11], s22 offen offset:3120 lds
    v_mfma_f32_16x16x32_bf16 a[104:107], v[160:163], v[128:131], a[104:107]
    v_exp_f32 v94, v94
    v_mfma_f32_16x16x32_bf16 a[104:107], v[164:167], v[132:135], a[104:107]
    v_exp_f32 v95, v95
    v_mfma_f32_16x16x32_bf16 a[168:171], v[160:163], v[136:139], a[168:171]
    s_add_u32 m0, s24, 4160
    s_add_u32 s22, s22, 4096
    v_mfma_f32_16x16x32_bf16 a[168:171], v[164:167], v[140:143], a[168:171]
    v_exp_f32 v108, v108
    v_mfma_f32_16x16x32_bf16 v[204:207], v[168:171], v[120:123], v[204:207]
    buffer_load_dwordx4 v3, s[8:11], s22 offen offset:0 lds
    v_mfma_f32_16x16x32_bf16 v[204:207], v[172:175], v[124:127], v[204:207]
    v_exp_f32 v109, v109
    v_mfma_f32_16x16x32_bf16 a[108:111], v[168:171], v[128:131], a[108:111]
    ds_read_b64_tr_b16 v[144:145], v2 offset:256
    ds_read_b64_tr_b16 v[146:147], v2 offset:1296
    v_mfma_f32_16x16x32_bf16 a[108:111], v[172:175], v[132:135], a[108:111]
    ds_read_b64_tr_b16 v[148:149], v2 offset:16896
    ds_read_b64_tr_b16 v[150:151], v2 offset:17936
    v_mfma_f32_16x16x32_bf16 a[172:175], v[168:171], v[136:139], a[172:175]
    ds_read_b64_tr_b16 v[152:153], v2 offset:288
    ds_read_b64_tr_b16 v[154:155], v2 offset:1328
    v_mfma_f32_16x16x32_bf16 a[172:175], v[172:175], v[140:143], a[172:175]
    ds_read_b64_tr_b16 v[156:157], v2 offset:16928
    s_waitcnt lgkmcnt(15)
    v_mfma_f32_16x16x32_bf16 v[208:211], v[176:179], v[120:123], v[208:211]
    ds_read_b64_tr_b16 v[158:159], v2 offset:17968
    v_mfma_f32_16x16x32_bf16 v[208:211], v[180:183], v[124:127], v[208:211]
    buffer_load_dwordx4 v4, s[8:11], s22 offen offset:1040 lds
    v_mfma_f32_16x16x32_bf16 a[112:115], v[176:179], v[128:131], a[112:115]
    v_exp_f32 v110, v110
    v_mfma_f32_16x16x32_bf16 a[112:115], v[180:183], v[132:135], a[112:115]
    v_exp_f32 v111, v111
    v_mfma_f32_16x16x32_bf16 a[176:179], v[176:179], v[136:139], a[176:179]
    v_fma_f32 v84, v36, s20, v7
    v_fma_f32 v85, v37, s20, v7
    v_mfma_f32_16x16x32_bf16 a[176:179], v[180:183], v[140:143], a[176:179]
    v_fma_f32 v86, v38, s20, v7
    v_fma_f32 v87, v39, s20, v7
    v_mfma_f32_16x16x32_bf16 v[212:215], v[184:187], v[120:123], v[212:215]
    buffer_load_dwordx4 v5, s[8:11], s22 offen offset:2080 lds
    v_mfma_f32_16x16x32_bf16 v[212:215], v[188:191], v[124:127], v[212:215]
    v_max3_f32 v13, v13, v84, v85
    v_max3_f32 v13, v13, v86, v87
    v_mfma_f32_16x16x32_bf16 a[116:119], v[184:187], v[128:131], a[116:119]
    ds_read_b64_tr_b16 v[160:161], v2 offset:320
    ds_read_b64_tr_b16 v[162:163], v2 offset:1360
    v_mfma_f32_16x16x32_bf16 a[116:119], v[188:191], v[132:135], a[116:119]
    ds_read_b64_tr_b16 v[164:165], v2 offset:16960
    ds_read_b64_tr_b16 v[166:167], v2 offset:18000
    v_mfma_f32_16x16x32_bf16 a[180:183], v[184:187], v[136:139], a[180:183]
    ds_read_b64_tr_b16 v[168:169], v2 offset:352
    ds_read_b64_tr_b16 v[170:171], v2 offset:1392
    v_mfma_f32_16x16x32_bf16 a[180:183], v[188:191], v[140:143], a[180:183]
    ds_read_b64_tr_b16 v[172:173], v2 offset:16992
    s_waitcnt lgkmcnt(15)
    v_mfma_f32_16x16x32_bf16 v[216:219], a[240:243], v[120:123], v[216:219]
    buffer_load_dwordx4 v6, s[8:11], s22 offen offset:3120 lds
    v_mfma_f32_16x16x32_bf16 v[216:219], a[244:247], v[124:127], v[216:219]
    ds_read_b64_tr_b16 v[174:175], v2 offset:18032
    v_fma_f32 v100, v52, s20, v8
    v_mfma_f32_16x16x32_bf16 a[120:123], a[240:243], v[128:131], a[120:123]
    v_fma_f32 v101, v53, s20, v8
    v_fma_f32 v102, v54, s20, v8
    v_mfma_f32_16x16x32_bf16 a[120:123], a[244:247], v[132:135], a[120:123]
    v_fma_f32 v103, v55, s20, v8
    v_max3_f32 v13, v13, v100, v101
    v_mfma_f32_16x16x32_bf16 a[184:187], a[240:243], v[136:139], a[184:187]
    v_max3_f32 v13, v13, v102, v103
    v_fma_f32 v116, v68, s20, v9
    v_mfma_f32_16x16x32_bf16 a[184:187], a[244:247], v[140:143], a[184:187]
    v_fma_f32 v117, v69, s20, v9
    v_fma_f32 v118, v70, s20, v9
    v_mfma_f32_16x16x32_bf16 v[220:223], a[248:251], v[120:123], v[220:223]
    s_add_u32 s22, s22, 28672
    s_add_u32 s24, s24, s26
    v_mfma_f32_16x16x32_bf16 v[220:223], a[252:255], v[124:127], v[220:223]
    v_fma_f32 v119, v71, s20, v9
    v_max3_f32 v13, v13, v116, v117
    v_mfma_f32_16x16x32_bf16 a[124:127], a[248:251], v[128:131], a[124:127]
    ds_read_b64_tr_b16 v[176:177], v2 offset:384
    ds_read_b64_tr_b16 v[178:179], v2 offset:1424
    v_mfma_f32_16x16x32_bf16 a[124:127], a[252:255], v[132:135], a[124:127]
    ds_read_b64_tr_b16 v[180:181], v2 offset:17024
    ds_read_b64_tr_b16 v[182:183], v2 offset:18064
    v_mfma_f32_16x16x32_bf16 a[188:191], a[248:251], v[136:139], a[188:191]
    ds_read_b64_tr_b16 v[184:185], v2 offset:416
    ds_read_b64_tr_b16 v[186:187], v2 offset:1456
    v_mfma_f32_16x16x32_bf16 a[188:191], a[252:255], v[140:143], a[188:191]
    ds_read_b64_tr_b16 v[188:189], v2 offset:17056
    s_waitcnt lgkmcnt(15)
    v_mfma_f32_16x16x32_bf16 v[224:227], v[144:147], v[120:123], v[224:227]
    v_max3_f32 v13, v13, v118, v119
    v_cmp_lt_f32 vcc, 0x41000000, v13
    v_mfma_f32_16x16x32_bf16 v[224:227], v[148:151], v[124:127], v[224:227]
    ds_read_b64_tr_b16 v[190:191], v2 offset:18096
    v_mfma_f32_16x16x32_bf16 a[128:131], v[144:147], v[128:131], a[128:131]
    s_cbranch_vccnz L_rare1_l0
L_back1_l0:
    v_mfma_f32_16x16x32_bf16 a[128:131], v[148:151], v[132:135], a[128:131]
    v_exp_f32 v80, v80
    v_mfma_f32_16x16x32_bf16 a[192:195], v[144:147], v[136:139], a[192:195]
    v_exp_f32 v81, v81
    v_mfma_f32_16x16x32_bf16 a[192:195], v[148:151], v[140:143], a[192:195]
    v_exp_f32 v82, v82
    v_mfma_f32_16x16x32_bf16 v[228:231], v[152:155], v[120:123], v[228:231]
    v_exp_f32 v83, v83
    v_mfma_f32_16x16x32_bf16 v[228:231], v[156:159], v[124:127], v[228:231]
    v_exp_f32 v96, v96
    v_mfma_f32_16x16x32_bf16 a[132:135], v[152:155], v[128:131], a[132:135]
    ds_read_b64_tr_b16 a[240:241], v2 offset:448
    ds_read_b64_tr_b16 a[242:243], v2 offset:1488
    v_mfma_f32_16x16x32_bf16 a[132:135], v[156:159], v[132:135], a[132:135]
    ds_read_b64_tr_b16 a[244:245], v2 offset:17088
    ds_read_b64_tr_b16 a[246:247], v2 offset:18128
    v_mfma_f32_16x16x32_bf16 a[196:199], v[152:155], v[136:139], a[196:199]
    ds_read_b64_tr_b16 a[248:249], v2 offset:480
    ds_read_b64_tr_b16 a[250:251], v2 offset:1520
    v_mfma_f32_16x16x32_bf16 a[196:199], v[156:159], v[140:143], a[196:199]
    ds_read_b64_tr_b16 a[252:253], v2 offset:17120
    s_waitcnt lgkmcnt(15)
    v_mfma_f32_16x16x32_bf16 v[232:235], v[160:163], v[120:123], v[232:235]
    ds_read_b64_tr_b16 a[254:255], v2 offset:18160
    v_mfma_f32_16x16x32_bf16 v[232:235], v[164:167], v[124:127], v[232:235]
    v_exp_f32 v97, v97
    v_mfma_f32_16x16x32_bf16 a[136:139], v[160:163], v[128:131], a[136:139]
    v_exp_f32 v98, v98
    v_mfma_f32_16x16x32_bf16 a[136:139], v[164:167], v[132:135], a[136:139]
    v_exp_f32 v99, v99
    v_mfma_f32_16x16x32_bf16 a[200:203], v[160:163], v[136:139], a[200:203]
    v_exp_f32 v112, v112
    v_mfma_f32_16x16x32_bf16 a[200:203], v[164:167], v[140:143], a[200:203]
    v_exp_f32 v113, v113
    v_mfma_f32_16x16x32_bf16 v[236:239], v[168:171], v[120:123], v[236:239]
    v_exp_f32 v114, v114
    v_mfma_f32_16x16x32_bf16 v[236:239], v[172:175], v[124:127], v[236:239]
    v_exp_f32 v115, v115
    v_mfma_f32_16x16x32_bf16 a[140:143], v[168:171], v[128:131], a[140:143]
    v_exp_f32 v84, v84
    v_mfma_f32_16x16x32_bf16 a[140:143], v[172:175], v[132:135], a[140:143]
    v_exp_f32 v85, v85
    v_mfma_f32_16x16x32_bf16 a[204:207], v[168:171], v[136:139], a[204:207]
    v_exp_f32 v86, v86
    v_mfma_f32_16x16x32_bf16 a[204:207], v[172:175], v[140:143], a[204:207]
    s_waitcnt lgkmcnt(8)
    v_mfma_f32_16x16x32_bf16 v[240:243], v[176:179], v[120:123], v[240:243]
    v_exp_f32 v87, v87
    v_mfma_f32_16x16x32_bf16 v[240:243], v[180:183], v[124:127], v[240:243]
    v_exp_f32 v100, v100
    v_mfma_f32_16x16x32_bf16 a[144:147], v[176:179], v[128:131], a[144:147]
    v_exp_f32 v101, v101
    v_mfma_f32_16x16x32_bf16 a[144:147], v[180:183], v[132:135], a[144:147]
    v_exp_f32 v102, v102
    v_mfma_f32_16x16x32_bf16 a[208:211], v[176:179], v[136:139], a[208:211]
    s_waitcnt vmcnt(16) lgkmcnt(0)
    s_barrier
    v_subrev_u32 v2, s26, v2
    v_mfma_f32_16x16x32_bf16 a[208:211], v[180:183], v[140:143], a[208:211]
    ds_read_b128 v[144:147], v1 offset:0
    ds_read_b128 v[148:151], v1 offset:64
    v_mfma_f32_16x16x32_bf16 v[244:247], v[184:187], v[120:123], v[244:247]
    v_exp_f32 v103, v103
    v_mfma_f32_16x16x32_bf16 v[244:247], v[188:191], v[124:127], v[244:247]
    ds_read_b128 v[152:155], v1 offset:128
    ds_read_b128 v[156:159], v1 offset:192
    v_mfma_f32_16x16x32_bf16 a[148:151], v[184:187], v[128:131], a[148:151]
    v_exp_f32 v116, v116
    v_mfma_f32_16x16x32_bf16 a[148:151], v[188:191], v[132:135], a[148:151]
    v_exp_f32 v117, v117
    v_mfma_f32_16x16x32_bf16 a[212:215], v[184:187], v[136:139], a[212:215]
    v_exp_f32 v118, v118
    v_mfma_f32_16x16x32_bf16 a[212:215], v[188:191], v[140:143], a[212:215]
    v_mfma_f32_16x16x32_bf16 v[248:251], a[240:243], v[120:123], v[248:251]
    v_exp_f32 v119, v119
    v_mfma_f32_16x16x32_bf16 v[248:251], a[244:247], v[124:127], v[248:251]
    v_mfma_f32_16x16x32_bf16 a[152:155], a[240:243], v[128:131], a[152:155]
    v_mfma_f32_16x16x32_bf16 a[152:155], a[244:247], v[132:135], a[152:155]
    v_mfma_f32_16x16x32_bf16 a[216:219], a[240:243], v[136:139], a[216:219]
    v_mfma_f32_16x16x32_bf16 a[216:219], a[244:247], v[140:143], a[216:219]
    v_mfma_f32_16x16x32_bf16 v[252:255], a[248:251], v[120:123], v[252:255]
    s_sub_u32 s26, 0, s26
    v_mfma_f32_16x16x32_bf16 v[252:255], a[252:255], v[124:127], v[252:255]
    s_add_u32 s21, s21, 1
    v_mfma_f32_16x16x32_bf16 a[156:159], a[248:251], v[128:131], a[156:159]
    s_lshl_b32 s47, s27, 8
    v_mfma_f32_16x16x32_bf16 a[156:159], a[252:255], v[132:135], a[156:159]
    s_or_b32 s47, s47, s21
    v_mfma_f32_16x16x32_bf16 a[220:223], a[248:251], v[136:139], a[220:223]
    s_cmp_lt_u32 s47, 6
    v_mfma_f32_16x16x32_bf16 a[220:223], a[252:255], v[140:143], a[220:223]
    s_cbranch_scc1 L_loop_l
    s_cmp_eq_u32 s27, 0
    s_cbranch_scc1 L_noresc
    s_call_b64 s[30:31], L_resc
    s_cmp_lt_u32 s21, 6
    s_cbranch_scc1 L_loop_l
L_noresc:
    s_waitcnt lgkmcnt(0)
    v_mfma_f32_16x16x32_bf16 v[24:27], v[144:147], a[0:3], 0
    ds_read_b128 v[160:163], v1 offset:256
    ds_read_b128 v[164:167], v1 offset:320
    v_mfma_f32_16x16x32_bf16 v[24:27], v[148:151], a[4:7], v[24:27]
    ds_read_b128 v[168:171], v1 offset:384
    ds_read_b128 v[172:175], v1 offset:448
    v_mfma_f32_16x16x32_bf16 v[24:27], v[152:155], a[8:11], v[24:27]
    ds_read_b128 v[176:179], v1 offset:1040
    ds_read_b128 v[180:183], v1 offset:1104
    v_mfma_f32_16x16x32_bf16 v[24:27], v[156:159], a[12:15], v[24:27]
    ds_read_b128 v[184:187], v1 offset:1168
    v_cvt_pk_bf16_f32 v120, v72, v73
    v_mfma_f32_16x16x32_bf16 v[40:43], v[144:147], a[32:35], 0
    ds_read_b128 v[188:191], v1 offset:1232
    v_cvt_pk_bf16_f32 v121, v74, v75
    v_mfma_f32_16x16x32_bf16 v[40:43], v[148:151], a[36:39], v[40:43]
    v_cvt_pk_bf16_f32 v122, v76, v77
    v_cvt_pk_bf16_f32 v123, v78, v79
    v_mfma_f32_16x16x32_bf16 v[40:43], v[152:155], a[40:43], v[40:43]
    s_mul_i32 s48, s28, 9216
    v_bfe_u32 v21, v17, 4, 4
    v_mfma_f32_16x16x32_bf16 v[40:43], v[156:159], a[44:47], v[40:43]
    v_mul_u32_u24 v21, 144, v21
    v_lshrrev_b32 v22, 8, v17
    v_mfma_f32_16x16x32_bf16 v[56:59], v[144:147], a[64:67], 0
    v_lshl_add_u32 v21, v22, 3, v21
    v_add_u32 v18, s48, v21
    v_mfma_f32_16x16x32_bf16 v[56:59], v[148:151], a[68:71], v[56:59]
    v_lshrrev_b32 v22, 7, v17
    v_mul_u32_u24 v21, 144, v22
    v_mfma_f32_16x16x32_bf16 v[56:59], v[152:155], a[72:75], v[56:59]
    v_and_b32 v23, 112, v17
    v_add3_u32 v19, v21, v23, s48
    v_mfma_f32_16x16x32_bf16 v[56:59], v[156:159], a[76:79], v[56:59]
    s_mul_i32 s48, s28, 24576
    s_waitcnt lgkmcnt(4)
    v_mfma_f32_16x16x32_bf16 v[24:27], v[160:163], a[16:19], v[24:27]
    v_lshl_add_u32 v21, v22, 9, v23
    v_add_u32 v20, s48, v21
    v_mfma_f32_16x16x32_bf16 v[24:27], v[164:167], a[20:23], v[24:27]
    s_mov_b32 s52, 0
    s_mov_b32 s53, 4096
    v_mfma_f32_16x16x32_bf16 v[24:27], v[168:171], a[24:27], v[24:27]
    s_mov_b32 s54, 8192
    s_mov_b32 s55, 12288
    v_mfma_f32_16x16x32_bf16 v[24:27], v[172:175], a[28:31], v[24:27]
    s_mov_b32 s56, 16384
    s_mov_b32 s57, 20480
    v_mfma_f32_16x16x32_bf16 v[40:43], v[160:163], a[48:51], v[40:43]
    v_cvt_pk_bf16_f32 v128, v88, v89
    v_cvt_pk_bf16_f32 v129, v90, v91
    v_mfma_f32_16x16x32_bf16 v[40:43], v[164:167], a[52:55], v[40:43]
    v_cvt_pk_bf16_f32 v130, v92, v93
    v_cvt_pk_bf16_f32 v131, v94, v95
    v_mfma_f32_16x16x32_bf16 v[40:43], v[168:171], a[56:59], v[40:43]
    v_cvt_pk_bf16_f32 v136, v104, v105
    v_cvt_pk_bf16_f32 v137, v106, v107
    v_mfma_f32_16x16x32_bf16 v[40:43], v[172:175], a[60:63], v[40:43]
    v_fma_f32 v72, v24, s20, v7
    v_fma_f32 v73, v25, s20, v7
    v_mfma_f32_16x16x32_bf16 v[56:59], v[160:163], a[80:83], v[56:59]
    v_fma_f32 v74, v26, s20, v7
    v_fma_f32 v75, v27, s20, v7
    v_mfma_f32_16x16x32_bf16 v[56:59], v[164:167], a[84:87], v[56:59]
    ds_read_b128 a[240:243], v1 offset:1296
    v_max3_f32 v13, v72, v73, v74
    v_mfma_f32_16x16x32_bf16 v[56:59], v[168:171], a[88:91], v[56:59]
    ds_read_b128 a[244:247], v1 offset:1360
    ds_read_b128 a[248:251], v1 offset:1424
    v_mfma_f32_16x16x32_bf16 v[56:59], v[172:175], a[92:95], v[56:59]
    ds_read_b128 a[252:255], v1 offset:1488
    s_waitcnt lgkmcnt(4)
    v_mfma_f32_16x16x32_bf16 v[28:31], v[176:179], a[0:3], 0
    v_max_f32 v13, v13, v75
    v_fma_f32 v88, v40, s20, v8
    v_mfma_f32_16x16x32_bf16 v[28:31], v[180:183], a[4:7], v[28:31]
    v_fma_f32 v89, v41, s20, v8
    v_fma_f32 v90, v42, s20, v8
    v_mfma_f32_16x16x32_bf16 v[28:31], v[184:187], a[8:11], v[28:31]
    v_cvt_pk_bf16_f32 v138, v108, v109
    v_cvt_pk_bf16_f32 v139, v110, v111
    v_mfma_f32_16x16x32_bf16 v[28:31], v[188:191], a[12:15], v[28:31]
    v_fma_f32 v91, v43, s20, v8
    v_max3_f32 v13, v13, v88, v89
    v_mfma_f32_16x16x32_bf16 v[44:47], v[176:179], a[32:35], 0
    v_max3_f32 v13, v13, v90, v91
    v_fma_f32 v104, v56, s20, v9
    v_mfma_f32_16x16x32_bf16 v[44:47], v[180:183], a[36:39], v[44:47]
    v_fma_f32 v105, v57, s20, v9
    v_fma_f32 v106, v58, s20, v9
    v_mfma_f32_16x16x32_bf16 v[44:47], v[184:187], a[40:43], v[44:47]
    v_fma_f32 v107, v59, s20, v9
    v_max3_f32 v13, v13, v104, v105
    v_mfma_f32_16x16x32_bf16 v[44:47], v[188:191], a[44:47], v[44:47]
    v_max3_f32 v13, v13, v106, v107
    s_mov_b32 m0, s25
    v_mfma_f32_16x16x32_bf16 v[60:63], v[176:179], a[64:67], 0
    ds_read_b128 v[144:147], v1 offset:16640
    ds_read_b128 v[148:151], v1 offset:16704
    v_mfma_f32_16x16x32_bf16 v[60:63], v[180:183], a[68:71], v[60:63]
    ds_read_b128 v[152:155], v1 offset:16768
    ds_read_b128 v[156:159], v1 offset:16832
    v_mfma_f32_16x16x32_bf16 v[60:63], v[184:187], a[72:75], v[60:63]
    buffer_load_dwordx4 v3, s[12:15], s23 offen offset:0 lds
    v_mfma_f32_16x16x32_bf16 v[60:63], v[188:191], a[76:79], v[60:63]
    ds_read_b128 v[160:163], v1 offset:16896
    s_waitcnt lgkmcnt(5)
    v_mfma_f32_16x16x32_bf16 v[28:31], a[240:243], a[16:19], v[28:31]
    buffer_load_dwordx4 v4, s[12:15], s23 offen offset:1040 lds
    v_mfma_f32_16x16x32_bf16 v[28:31], a[244:247], a[20:23], v[28:31]
    buffer_load_dwordx4 v5, s[12:15], s23 offen offset:2080 lds
    v_mfma_f32_16x16x32_bf16 v[28:31], a[248:251], a[24:27], v[28:31]
    buffer_load_dwordx4 v6, s[12:15], s23 offen offset:3120 lds
    v_mfma_f32_16x16x32_bf16 v[28:31], a[252:255], a[28:31], v[28:31]
    ds_read_b128 v[164:167], v1 offset:16960
    ds_read_b128 v[168:171], v1 offset:17024
    v_mfma_f32_16x16x32_bf16 v[44:47], a[240:243], a[48:51], v[44:47]
    s_add_u32 m0, s25, 4160
    s_add_u32 s23, s23, 4096
    v_mfma_f32_16x16x32_bf16 v[44:47], a[244:247], a[52:55], v[44:47]
    ds_read_b128 v[172:175], v1 offset:17088
    v_cvt_pk_bf16_f32 v124, v80, v81
    v_mfma_f32_16x16x32_bf16 v[44:47], a[248:251], a[56:59], v[44:47]
    buffer_load_dwordx4 v3, s[12:15], s23 offen offset:0 lds
    v_mfma_f32_16x16x32_bf16 v[44:47], a[252:255], a[60:63], v[44:47]
    v_fma_f32 v76, v28, s20, v7
    v_fma_f32 v77, v29, s20, v7
    v_mfma_f32_16x16x32_bf16 v[60:63], a[240:243], a[80:83], v[60:63]
    v_fma_f32 v78, v30, s20, v7
    v_fma_f32 v79, v31, s20, v7
    v_mfma_f32_16x16x32_bf16 v[60:63], a[244:247], a[84:87], v[60:63]
    v_max3_f32 v13, v13, v76, v77
    v_max3_f32 v13, v13, v78, v79
    v_mfma_f32_16x16x32_bf16 v[60:63], a[248:251], a[88:91], v[60:63]
    buffer_load_dwordx4 v4, s[12:15], s23 offen offset:1040 lds
    v_mfma_f32_16x16x32_bf16 v[60:63], a[252:255], a[92:95], v[60:63]
    v_fma_f32 v92, v44, s20, v8
    s_waitcnt lgkmcnt(4)
    v_mfma_f32_16x16x32_bf16 v[32:35], v[144:147], a[0:3], 0
    v_fma_f32 v93, v45, s20, v8
    v_fma_f32 v94, v46, s20, v8
    v_mfma_f32_16x16x32_bf16 v[32:35], v[148:151], a[4:7], v[32:35]
    v_fma_f32 v95, v47, s20, v8
    v_max3_f32 v13, v13, v92, v93
    v_mfma_f32_16x16x32_bf16 v[32:35], v[152:155], a[8:11], v[32:35]
    buffer_load_dwordx4 v5, s[12:15], s23 offen offset:2080 lds
    v_mfma_f32_16x16x32_bf16 v[32:35], v[156:159], a[12:15], v[32:35]
    buffer_load_dwordx4 v6, s[12:15], s23 offen offset:3120 lds
    v_mfma_f32_16x16x32_bf16 v[48:51], v[144:147], a[32:35], 0
    v_max3_f32 v13, v13, v94, v95
    v_fma_f32 v108, v60, s20, v9
    v_mfma_f32_16x16x32_bf16 v[48:51], v[148:151], a[36:39], v[48:51]
    v_fma_f32 v109, v61, s20, v9
    v_fma_f32 v110, v62, s20, v9
    v_mfma_f32_16x16x32_bf16 v[48:51], v[152:155], a[40:43], v[48:51]
    v_fma_f32 v111, v63, s20, v9
    v_max3_f32 v13, v13, v108, v109
    v_mfma_f32_16x16x32_bf16 v[48:51], v[156:159], a[44:47], v[48:51]
    v_max3_f32 v13, v13, v110, v111
    v_cmp_lt_f32 vcc, 0x41000000, v13
    v_mfma_f32_16x16x32_bf16 v[64:67], v[144:147], a[64:67], 0
    s_cbranch_vccnz L_rare0_z0
L_back0_z0:
    ds_read_b128 v[176:179], v1 offset:17680
    v_mfma_f32_16x16x32_bf16 v[64:67], v[148:151], a[68:71], v[64:67]
    v_exp_f32 v72, v72
    v_mfma_f32_16x16x32_bf16 v[64:67], v[152:155], a[72:75], v[64:67]
    ds_read_b128 v[180:183], v1 offset:17744
    ds_read_b128 v[184:187], v1 offset:17808
    v_mfma_f32_16x16x32_bf16 v[64:67], v[156:159], a[76:79], v[64:67]
    s_add_u32 s23, s23, 28672
    s_add_u32 s25, s25, s26
    s_waitcnt lgkmcnt(3)
    v_mfma_f32_16x16x32_bf16 v[32:35], v[160:163], a[16:19], v[32:35]
    ds_read_b128 v[188:191], v1 offset:17872
    v_cvt_pk_bf16_f32 v125, v82, v83
    v_mfma_f32_16x16x32_bf16 v[32:35], v[164:167], a[20:23], v[32:35]
    v_exp_f32 v73, v73
    v_mfma_f32_16x16x32_bf16 v[32:35], v[168:171], a[24:27], v[32:35]
    v_exp_f32 v74, v74
    v_mfma_f32_16x16x32_bf16 v[32:35], v[172:175], a[28:31], v[32:35]
    ds_read_b128 a[240:243], v1 offset:17936
    v_cvt_pk_bf16_f32 v126, v84, v85
    v_mfma_f32_16x16x32_bf16 v[48:51], v[160:163], a[48:51], v[48:51]
    ds_read_b128 a[244:247], v1 offset:18000
    ds_read_b128 a[248:251], v1 offset:18064
    v_mfma_f32_16x16x32_bf16 v[48:51], v[164:167], a[52:55], v[48:51]
    ds_read_b128 a[252:255], v1 offset:18128
    v_cvt_pk_bf16_f32 v127, v86, v87
    v_mfma_f32_16x16x32_bf16 v[48:51], v[168:171], a[56:59], v[48:51]
    v_exp_f32 v75, v75
    v_mfma_f32_16x16x32_bf16 v[48:51], v[172:175], a[60:63], v[48:51]
    v_exp_f32 v88, v88
    v_mfma_f32_16x16x32_bf16 v[64:67], v[160:163], a[80:83], v[64:67]
    v_exp_f32 v89, v89
    v_mfma_f32_16x16x32_bf16 v[64:67], v[164:167], a[84:87], v[64:67]
    v_exp_f32 v90, v90
    v_mfma_f32_16x16x32_bf16 v[64:67], v[168:171], a[88:91], v[64:67]
    v_cvt_pk_bf16_f32 v132, v96, v97
    v_cvt_pk_bf16_f32 v133, v98, v99
    v_cvt_pk_bf16_f32 v134, v100, v101
    v_cvt_pk_bf16_f32 v135, v102, v103
    v_mfma_f32_16x16x32_bf16 v[64:67], v[172:175], a[92:95], v[64:67]
    v_cvt_pk_bf16_f32 v140, v112, v113
    s_waitcnt lgkmcnt(4)
    v_mfma_f32_16x16x32_bf16 v[36:39], v[176:179], a[0:3], 0
    v_exp_f32 v91, v91
    v_mfma_f32_16x16x32_bf16 v[36:39], v[180:183], a[4:7], v[36:39]
    v_exp_f32 v104, v104
    v_mfma_f32_16x16x32_bf16 v[36:39], v[184:187], a[8:11], v[36:39]
    v_cvt_pk_bf16_f32 v141, v114, v115
    v_cvt_pk_bf16_f32 v142, v116, v117
    v_cvt_pk_bf16_f32 v143, v118, v119
    v_mfma_f32_16x16x32_bf16 v[36:39], v[188:191], a[12:15], v[36:39]
    v_fma_f32 v80, v32, s20, v7
    v_fma_f32 v81, v33, s20, v7
    v_mfma_f32_16x16x32_bf16 v[52:55], v[176:179], a[32:35], 0
    v_fma_f32 v82, v34, s20, v7
    v_mfma_f32_16x16x32_bf16 v[52:55], v[180:183], a[36:39], v[52:55]
    v_exp_f32 v105, v105
    v_mfma_f32_16x16x32_bf16 v[52:55], v[184:187], a[40:43], v[52:55]
    v_fma_f32 v83, v35, s20, v7
    v_max3_f32 v13, v80, v81, v82
    v_mfma_f32_16x16x32_bf16 v[52:55], v[188:191], a[44:47], v[52:55]
    v_max_f32 v13, v13, v83
    v_mfma_f32_16x16x32_bf16 v[68:71], v[176:179], a[64:67], 0
    s_waitcnt vmcnt(16) lgkmcnt(0)
    s_barrier
    v_mfma_f32_16x16x32_bf16 v[68:71], v[180:183], a[68:71], v[68:71]
    v_exp_f32 v106, v106
    v_mfma_f32_16x16x32_bf16 v[68:71], v[184:187], a[72:75], v[68:71]
    v_fma_f32 v96, v48, s20, v8
    v_fma_f32 v97, v49, s20, v8
    v_mfma_f32_16x16x32_bf16 v[68:71], v[188:191], a[76:79], v[68:71]
    v_fma_f32 v98, v50, s20, v8
    v_mfma_f32_16x16x32_bf16 v[36:39], a[240:243], a[16:19], v[36:39]
    ds_read_b64_tr_b16 v[144:145], v2 offset:0
    ds_read_b64_tr_b16 v[146:147], v2 offset:1040
    v_mfma_f32_16x16x32_bf16 v[36:39], a[244:247], a[20:23], v[36:39]
    v_exp_f32 v107, v107
    v_mfma_f32_16x16x32_bf16 v[36:39], a[248:251], a[24:27], v[36:39]
    ds_read_b64_tr_b16 v[148:149], v2 offset:16640
    ds_read_b64_tr_b16 v[150:151], v2 offset:17680
    v_mfma_f32_16x16x32_bf16 v[36:39], a[252:255], a[28:31], v[36:39]
    ds_read_b64_tr_b16 v[152:153], v2 offset:32
    v_fma_f32 v99, v51, s20, v8
    v_mfma_f32_16x16x32_bf16 v[52:55], a[240:243], a[48:51], v[52:55]
    ds_read_b64_tr_b16 v[154:155], v2 offset:1072
    ds_read_b64_tr_b16 v[156:157], v2 offset:16672
    v_mfma_f32_16x16x32_bf16 v[52:55], a[244:247], a[52:55], v[52:55]
    ds_read_b64_tr_b16 v[158:159], v2 offset:17712
    v_max3_f32 v13, v13, v96, v97
    v_mfma_f32_16x16x32_bf16 v[52:55], a[248:251], a[56:59], v[52:55]
    v_max3_f32 v13, v13, v98, v99
    v_mfma_f32_16x16x32_bf16 v[52:55], a[252:255], a[60:63], v[52:55]
    v_exp_f32 v76, v76
    v_mfma_f32_16x16x32_bf16 v[68:71], a[240:243], a[80:83], v[68:71]
    v_fma_f32 v112, v64, s20, v9
    v_fma_f32 v113, v65, s20, v9
    v_mfma_f32_16x16x32_bf16 v[68:71], a[244:247], a[84:87], v[68:71]
    v_fma_f32 v114, v66, s20, v9
    v_mfma_f32_16x16x32_bf16 v[68:71], a[248:251], a[88:91], v[68:71]
    v_exp_f32 v77, v77
    v_mfma_f32_16x16x32_bf16 v[68:71], a[252:255], a[92:95], v[68:71]
    v_fma_f32 v115, v67, s20, v9
    v_max3_f32 v13, v13, v112, v113
    v_mfma_f32_16x16x32_bf16 a[224:227], a[236:239], v[120:123], a[224:227]
    ds_read_b64_tr_b16 v[160:161], v2 offset:64
    v_max3_f32 v13, v13, v114, v115
    v_exp_f32 v78, v78
    v_mfma_f32_16x16x32_bf16 a[224:227], a[236:239], v[124:127], a[224:227]
    ds_read_b64_tr_b16 v[162:163], v2 offset:1104
    v_exp_f32 v79, v79
    v_mfma_f32_16x16x32_bf16 a[228:231], a[236:239], v[128:131], a[228:231]
    ds_read_b64_tr_b16 v[164:165], v2 offset:16704
    ds_read_b64_tr_b16 v[166:167], v2 offset:17744
    v_exp_f32 v92, v92
    v_mfma_f32_16x16x32_bf16 a[228:231], a[236:239], v[132:135], a[228:231]
    ds_read_b64_tr_b16 v[168:169], v2 offset:96
    v_exp_f32 v93, v93
    v_mfma_f32_16x16x32_bf16 a[232:235], a[236:239], v[136:139], a[232:235]
    ds_read_b64_tr_b16 v[170:171], v2 offset:1136
    ds_read_b64_tr_b16 v[172:173], v2 offset:16736
    v_exp_f32 v94, v94
    v_mfma_f32_16x16x32_bf16 a[232:235], a[236:239], v[140:143], a[232:235]
    ds_read_b64_tr_b16 v[174:175], v2 offset:17776
    v_exp_f32 v95, v95
    s_waitcnt lgkmcnt(8)
    v_mfma_f32_16x16x32_bf16 v[192:195], v[144:147], v[120:123], v[192:195]
    v_exp_f32 v108, v108
    v_exp_f32 v109, v109
    v_mfma_f32_16x16x32_bf16 v[192:195], v[148:151], v[124:127], v[192:195]
    v_exp_f32 v110, v110
    v_exp_f32 v111, v111
    v_mfma_f32_16x16x32_bf16 a[96:99], v[144:147], v[128:131], a[96:99]
    v_fma_f32 v84, v36, s20, v7
    v_fma_f32 v85, v37, s20, v7
    v_fma_f32 v86, v38, s20, v7
    v_fma_f32 v87, v39, s20, v7
    v_mfma_f32_16x16x32_bf16 a[96:99], v[148:151], v[132:135], a[96:99]
    v_max3_f32 v13, v13, v84, v85
    v_max3_f32 v13, v13, v86, v87
    v_fma_f32 v100, v52, s20, v8
    v_fma_f32 v101, v53, s20, v8
    v_mfma_f32_16x16x32_bf16 a[160:163], v[144:147], v[136:139], a[160:163]
    v_fma_f32 v102, v54, s20, v8
    v_fma_f32 v103, v55, s20, v8
    v_max3_f32 v13, v13, v100, v101
    v_max3_f32 v13, v13, v102, v103
    v_mfma_f32_16x16x32_bf16 a[160:163], v[148:151], v[140:143], a[160:163]
    v_fma_f32 v116, v68, s20, v9
    v_fma_f32 v117, v69, s20, v9
    v_fma_f32 v118, v70, s20, v9
    v_fma_f32 v119, v71, s20, v9
    v_mfma_f32_16x16x32_bf16 v[196:199], v[152:155], v[120:123], v[196:199]
    v_max3_f32 v13, v13, v116, v117
    v_max3_f32 v13, v13, v118, v119
    v_cmp_lt_f32 vcc, 0x41000000, v13
    s_cbranch_vccnz L_rare1_z0
L_back1_z0:
    v_mfma_f32_16x16x32_bf16 v[196:199], v[156:159], v[124:127], v[196:199]
    v_exp_f32 v80, v80
    v_exp_f32 v81, v81
    v_mfma_f32_16x16x32_bf16 a[100:103], v[152:155], v[128:131], a[100:103]
    v_cvt_pk_bf16_f32 v24, v72, v73
    v_exp_f32 v82, v82
    v_mfma_f32_16x16x32_bf16 a[100:103], v[156:159], v[132:135], a[100:103]
    v_exp_f32 v83, v83
    v_cvt_pk_bf16_f32 v25, v74, v75
    v_mfma_f32_16x16x32_bf16 a[164:167], v[152:155], v[136:139], a[164:167]
    v_exp_f32 v96, v96
    v_exp_f32 v97, v97
    v_mfma_f32_16x16x32_bf16 a[164:167], v[156:159], v[140:143], a[164:167]
    v_cvt_pk_bf16_f32 v26, v76, v77
    v_exp_f32 v98, v98
    s_waitcnt lgkmcnt(0)
    v_mfma_f32_16x16x32_bf16 v[200:203], v[160:163], v[120:123], v[200:203]
    v_exp_f32 v99, v99
    v_cvt_pk_bf16_f32 v27, v78, v79
    v_mfma_f32_16x16x32_bf16 v[200:203], v[164:167], v[124:127], v[200:203]
    v_exp_f32 v112, v112
    v_exp_f32 v113, v113
    v_mfma_f32_16x16x32_bf16 a[104:107], v[160:163], v[128:131], a[104:107]
    v_cvt_pk_bf16_f32 v40, v88, v89
    v_exp_f32 v114, v114
    v_mfma_f32_16x16x32_bf16 a[104:107], v[164:167], v[132:135], a[104:107]
    v_exp_f32 v115, v115
    v_cvt_pk_bf16_f32 v41, v90, v91
    v_mfma_f32_16x16x32_bf16 a[168:171], v[160:163], v[136:139], a[168:171]
    s_waitcnt vmcnt(0)
    s_barrier
    ds_read_b64_tr_b16 v[176:177], v2 offset:33280
    ds_read_b64_tr_b16 v[178:179], v2 offset:34320
    v_mfma_f32_16x16x32_bf16 a[168:171], v[164:167], v[140:143], a[168:171]
    ds_read_b64_tr_b16 v[180:181], v2 offset:49920
    ds_read_b64_tr_b16 v[182:183], v2 offset:50960
    ds_read_b64_tr_b16 v[184:185], v2 offset:33312
    ds_read_b64_tr_b16 v[186:187], v2 offset:34352
    v_mfma_f32_16x16x32_bf16 v[204:207], v[168:171], v[120:123], v[204:207]
    ds_read_b64_tr_b16 v[188:189], v2 offset:49952
    ds_read_b64_tr_b16 v[190:191], v2 offset:50992
    v_exp_f32 v84, v84
    v_mfma_f32_16x16x32_bf16 v[204:207], v[172:175], v[124:127], v[204:207]
    v_exp_f32 v85, v85
    v_cvt_pk_bf16_f32 v42, v92, v93
    v_mfma_f32_16x16x32_bf16 a[108:111], v[168:171], v[128:131], a[108:111]
    v_exp_f32 v86, v86
    v_exp_f32 v87, v87
    v_mfma_f32_16x16x32_bf16 a[108:111], v[172:175], v[132:135], a[108:111]
    v_cvt_pk_bf16_f32 v43, v94, v95
    v_exp_f32 v100, v100
    v_mfma_f32_16x16x32_bf16 a[172:175], v[168:171], v[136:139], a[172:175]
    v_exp_f32 v101, v101
    v_cvt_pk_bf16_f32 v56, v104, v105
    v_exp_f32 v102, v102
    v_exp_f32 v103, v103
    v_cvt_pk_bf16_f32 v57, v106, v107
    v_exp_f32 v116, v116
    v_exp_f32 v117, v117
    v_cvt_pk_bf16_f32 v58, v108, v109
    v_exp_f32 v118, v118
    v_exp_f32 v119, v119
    v_cvt_pk_bf16_f32 v59, v110, v111
    v_cvt_pk_bf16_f32 v28, v80, v81
    v_cvt_pk_bf16_f32 v29, v82, v83
    v_cvt_pk_bf16_f32 v30, v84, v85
    v_cvt_pk_bf16_f32 v31, v86, v87
    v_cvt_pk_bf16_f32 v44, v96, v97
    v_cvt_pk_bf16_f32 v45, v98, v99
    v_cvt_pk_bf16_f32 v46, v100, v101
    v_cvt_pk_bf16_f32 v47, v102, v103
    v_cvt_pk_bf16_f32 v60, v112, v113
    v_cvt_pk_bf16_f32 v61, v114, v115
    v_cvt_pk_bf16_f32 v62, v116, v117
    v_cvt_pk_bf16_f32 v63, v118, v119
    v_mfma_f32_16x16x32_bf16 a[172:175], v[172:175], v[140:143], a[172:175]
    s_cmp_lg_u32 s27, 0
    s_cbranch_scc1 L_resc_z
L_rescback_z:
    ds_read_b64_tr_b16 a[240:241], v2 offset:33344
    ds_read_b64_tr_b16 a[242:243], v2 offset:34384
    v_mfma_f32_16x16x32_bf16 a[224:227], a[236:239], v[24:27], a[224:227]
    ds_read_b64_tr_b16 a[244:245], v2 offset:49984
    ds_read_b64_tr_b16 a[246:247], v2 offset:51024
    ds_read_b64_tr_b16 a[248:249], v2 offset:33376
    ds_read_b64_tr_b16 a[250:251], v2 offset:34416
    v_mfma_f32_16x16x32_bf16 a[224:227], a[236:239], v[28:31], a[224:227]
    ds_read_b64_tr_b16 a[252:253], v2 offset:50016
    ds_read_b64_tr_b16 a[254:255], v2 offset:51056
    v_mfma_f32_16x16x32_bf16 a[228:231], a[236:239], v[40:43], a[228:231]
    ds_read_b64_tr_b16 v[144:145], v2 offset:128
    ds_read_b64_tr_b16 v[146:147], v2 offset:1168
    ds_read_b64_tr_b16 v[148:149], v2 offset:16768
    ds_read_b64_tr_b16 v[150:151], v2 offset:17808
    v_mfma_f32_16x16x32_bf16 a[228:231], a[236:239], v[44:47], a[228:231]
    ds_read_b64_tr_b16 v[152:153], v2 offset:33408
    ds_read_b64_tr_b16 v[154:155], v2 offset:34448
    ds_read_b64_tr_b16 v[156:157], v2 offset:50048
    ds_read_b64_tr_b16 v[158:159], v2 offset:51088
    v_mfma_f32_16x16x32_bf16 a[232:235], a[236:239], v[56:59], a[232:235]
    v_mfma_f32_16x16x32_bf16 a[232:235], a[236:239], v[60:63], a[232:235]
    v_accvgpr_read_b32 v10, a224
    v_rcp_f32 v10, v10
    s_waitcnt lgkmcnt(15)
    v_mfma_f32_16x16x32_bf16 v[192:195], v[176:179], v[24:27], v[192:195]
    v_mfma_f32_16x16x32_bf16 v[192:195], v[180:183], v[28:31], v[192:195]
    v_accvgpr_read_b32 v11, a228
    v_rcp_f32 v11, v11
    v_mfma_f32_16x16x32_bf16 a[96:99], v[176:179], v[40:43], a[96:99]
    v_mfma_f32_16x16x32_bf16 a[96:99], v[180:183], v[44:47], a[96:99]
    v_accvgpr_read_b32 v12, a232
    v_rcp_f32 v12, v12
    v_mfma_f32_16x16x32_bf16 a[160:163], v[176:179], v[56:59], a[160:163]
    v_mfma_f32_16x16x32_bf16 a[160:163], v[180:183], v[60:63], a[160:163]
    v_mfma_f32_16x16x32_bf16 v[196:199], v[184:187], v[24:27], v[196:199]
    v_mfma_f32_16x16x32_bf16 v[196:199], v[188:191], v[28:31], v[196:199]
    v_mfma_f32_16x16x32_bf16 a[100:103], v[184:187], v[40:43], a[100:103]
    ds_read_b64_tr_b16 v[160:161], v2 offset:160
    ds_read_b64_tr_b16 v[162:163], v2 offset:1200
    ds_read_b64_tr_b16 v[164:165], v2 offset:16800
    ds_read_b64_tr_b16 v[166:167], v2 offset:17840
    v_mfma_f32_16x16x32_bf16 a[100:103], v[188:191], v[44:47], a[100:103]
    ds_read_b64_tr_b16 v[168:169], v2 offset:33440
    ds_read_b64_tr_b16 v[170:171], v2 offset:34480
    ds_read_b64_tr_b16 v[172:173], v2 offset:50080
    ds_read_b64_tr_b16 v[174:175], v2 offset:51120
    v_mfma_f32_16x16x32_bf16 a[164:167], v[184:187], v[56:59], a[164:167]
    v_mfma_f32_16x16x32_bf16 a[164:167], v[188:191], v[60:63], a[164:167]
    s_waitcnt lgkmcnt(15)
    v_mfma_f32_16x16x32_bf16 v[200:203], a[240:243], v[24:27], v[200:203]
    v_mfma_f32_16x16x32_bf16 v[200:203], a[244:247], v[28:31], v[200:203]
    v_mfma_f32_16x16x32_bf16 a[104:107], a[240:243], v[40:43], a[104:107]
    v_mfma_f32_16x16x32_bf16 a[104:107], a[244:247], v[44:47], a[104:107]
    v_mfma_f32_16x16x32_bf16 a[168:171], a[240:243], v[56:59], a[168:171]
    v_mfma_f32_16x16x32_bf16 a[168:171], a[244:247], v[60:63], a[168:171]
    v_mfma_f32_16x16x32_bf16 v[204:207], a[248:251], v[24:27], v[204:207]
    v_mfma_f32_16x16x32_bf16 v[204:207], a[252:255], v[28:31], v[204:207]
    v_mfma_f32_16x16x32_bf16 a[108:111], a[248:251], v[40:43], a[108:111]
    ds_read_b64_tr_b16 v[176:177], v2 offset:192
    ds_read_b64_tr_b16 v[178:179], v2 offset:1232
    ds_read_b64_tr_b16 v[180:181], v2 offset:16832
    ds_read_b64_tr_b16 v[182:183], v2 offset:17872
    v_mfma_f32_16x16x32_bf16 a[108:111], a[252:255], v[44:47], a[108:111]
    ds_read_b64_tr_b16 v[184:185], v2 offset:33472
    ds_read_b64_tr_b16 v[186:187], v2 offset:34512
    ds_read_b64_tr_b16 v[188:189], v2 offset:50112
    ds_read_b64_tr_b16 v[190:191], v2 offset:51152
    v_mfma_f32_16x16x32_bf16 a[172:175], a[248:251], v[56:59], a[172:175]
    v_mfma_f32_16x16x32_bf16 a[172:175], a[252:255], v[60:63], a[172:175]
    v_mul_f32 v192, v192, v10
    v_mul_f32 v193, v193, v10
    v_mul_f32 v194, v194, v10
    s_waitcnt lgkmcnt(15)
    v_mfma_f32_16x16x32_bf16 v[208:211], v[144:147], v[120:123], v[208:211]
    v_mul_f32 v195, v195, v10
    v_cvt_pk_bf16_f32 v104, v192, v193
    v_cvt_pk_bf16_f32 v105, v194, v195
    v_mfma_f32_16x16x32_bf16 v[208:211], v[148:151], v[124:127], v[208:211]
    ds_write_b64 v18, v[104:105] offset:0
    v_mul_f32 v196, v196, v10
    v_mul_f32 v197, v197, v10
    v_mfma_f32_16x16x32_bf16 v[208:211], v[152:155], v[24:27], v[208:211]
    v_mul_f32 v198, v198, v10
    v_mul_f32 v199, v199, v10
    v_cvt_pk_bf16_f32 v106, v196, v197
    v_cvt_pk_bf16_f32 v107, v198, v199
    v_mfma_f32_16x16x32_bf16 v[208:211], v[156:159], v[28:31], v[208:211]
    ds_write_b64 v18, v[106:107] offset:32
    v_mul_f32 v200, v200, v10
    v_mul_f32 v201, v201, v10
    v_mfma_f32_16x16x32_bf16 a[112:115], v[144:147], v[128:131], a[112:115]
    v_mul_f32 v202, v202, v10
    v_mul_f32 v203, v203, v10
    v_cvt_pk_bf16_f32 v108, v200, v201
    v_cvt_pk_bf16_f32 v109, v202, v203
    v_mfma_f32_16x16x32_bf16 a[112:115], v[148:151], v[132:135], a[112:115]
    ds_write_b64 v18, v[108:109] offset:64
    v_mul_f32 v204, v204, v10
    v_mul_f32 v205, v205, v10
    v_mfma_f32_16x16x32_bf16 a[112:115], v[152:155], v[40:43], a[112:115]
    v_mul_f32 v206, v206, v10
    v_mul_f32 v207, v207, v10
    v_cvt_pk_bf16_f32 v110, v204, v205
    v_cvt_pk_bf16_f32 v111, v206, v207
    v_mfma_f32_16x16x32_bf16 a[112:115], v[156:159], v[44:47], a[112:115]
    ds_write_b64 v18, v[110:111] offset:96
    ds_read_b128 v[32:35], v19 offset:0
    ds_read_b128 v[36:39], v19 offset:1152
    v_mfma_f32_16x16x32_bf16 a[176:179], v[144:147], v[136:139], a[176:179]
    v_accvgpr_read_b32 v88, a96
    v_accvgpr_read_b32 v89, a97
    v_accvgpr_read_b32 v90, a98
    v_accvgpr_read_b32 v91, a99
    v_mfma_f32_16x16x32_bf16 a[176:179], v[148:151], v[140:143], a[176:179]
    v_mul_f32 v88, v88, v11
    v_mul_f32 v89, v89, v11
    v_mul_f32 v90, v90, v11
    v_mul_f32 v91, v91, v11
    v_mfma_f32_16x16x32_bf16 a[176:179], v[152:155], v[56:59], a[176:179]
    v_cvt_pk_bf16_f32 v112, v88, v89
    v_cvt_pk_bf16_f32 v113, v90, v91
    v_mfma_f32_16x16x32_bf16 a[176:179], v[156:159], v[60:63], a[176:179]
    ds_write_b64 v18, v[112:113] offset:2304
    v_accvgpr_read_b32 v92, a100
    s_waitcnt lgkmcnt(15)
    v_mfma_f32_16x16x32_bf16 v[212:215], v[160:163], v[120:123], v[212:215]
    v_accvgpr_read_b32 v93, a101
    v_accvgpr_read_b32 v94, a102
    v_accvgpr_read_b32 v95, a103
    v_mul_f32 v92, v92, v11
    v_mfma_f32_16x16x32_bf16 v[212:215], v[164:167], v[124:127], v[212:215]
    s_waitcnt lgkmcnt(2)
    buffer_store_dwordx4 v[32:35], v20, s[16:19], s52 offen offset:0 nt
    s_waitcnt lgkmcnt(1)
    buffer_store_dwordx4 v[36:39], v20, s[16:19], s53 offen offset:0 nt
    v_mul_f32 v93, v93, v11
    v_mul_f32 v94, v94, v11
    v_mfma_f32_16x16x32_bf16 v[212:215], v[168:171], v[24:27], v[212:215]
    v_mul_f32 v95, v95, v11
    v_cvt_pk_bf16_f32 v114, v92, v93
    v_cvt_pk_bf16_f32 v115, v94, v95
    v_mfma_f32_16x16x32_bf16 v[212:215], v[172:175], v[28:31], v[212:215]
    ds_write_b64 v18, v[114:115] offset:2336
    v_accvgpr_read_b32 v96, a104
    v_accvgpr_read_b32 v97, a105
    v_mfma_f32_16x16x32_bf16 a[116:119], v[160:163], v[128:131], a[116:119]
    v_accvgpr_read_b32 v98, a106
    v_accvgpr_read_b32 v99, a107
    v_mul_f32 v96, v96, v11
    v_mul_f32 v97, v97, v11
    v_mfma_f32_16x16x32_bf16 a[116:119], v[164:167], v[132:135], a[116:119]
    v_mul_f32 v98, v98, v11
    v_mul_f32 v99, v99, v11
    v_cvt_pk_bf16_f32 v116, v96, v97
    v_cvt_pk_bf16_f32 v117, v98, v99
    v_mfma_f32_16x16x32_bf16 a[116:119], v[168:171], v[40:43], a[116:119]
    ds_write_b64 v18, v[116:117] offset:2368
    ds_read_b64_tr_b16 a[240:241], v2 offset:224
    v_accvgpr_read_b32 v100, a108
    v_mfma_f32_16x16x32_bf16 a[116:119], v[172:175], v[44:47], a[116:119]
    ds_read_b64_tr_b16 a[242:243], v2 offset:1264
    v_accvgpr_read_b32 v101, a109
    v_accvgpr_read_b32 v102, a110
    v_accvgpr_read_b32 v103, a111
    v_mfma_f32_16x16x32_bf16 a[180:183], v[160:163], v[136:139], a[180:183]
    ds_read_b64_tr_b16 a[244:245], v2 offset:16864
    ds_read_b64_tr_b16 a[246:247], v2 offset:17904
    v_mul_f32 v100, v100, v11
    v_mul_f32 v101, v101, v11
    v_mfma_f32_16x16x32_bf16 a[180:183], v[164:167], v[140:143], a[180:183]
    ds_read_b64_tr_b16 a[248:249], v2 offset:33504
    v_mul_f32 v102, v102, v11
    v_mul_f32 v103, v103, v11
    v_cvt_pk_bf16_f32 v118, v100, v101
    v_mfma_f32_16x16x32_bf16 a[180:183], v[168:171], v[56:59], a[180:183]
    ds_read_b64_tr_b16 a[250:251], v2 offset:34544
    ds_read_b64_tr_b16 a[252:253], v2 offset:50144
    v_cvt_pk_bf16_f32 v119, v102, v103
    v_mfma_f32_16x16x32_bf16 a[180:183], v[172:175], v[60:63], a[180:183]
    ds_write_b64 v18, v[118:119] offset:2400
    ds_read_b128 v[48:51], v19 offset:2304
    v_mfma_f32_16x16x32_bf16 v[216:219], v[176:179], v[120:123], v[216:219]
    ds_read_b128 v[52:55], v19 offset:3456
    ds_read_b64_tr_b16 a[254:255], v2 offset:51184
    v_accvgpr_read_b32 v72, a160
    v_accvgpr_read_b32 v73, a161
    v_mfma_f32_16x16x32_bf16 v[216:219], v[180:183], v[124:127], v[216:219]
    v_accvgpr_read_b32 v74, a162
    v_accvgpr_read_b32 v75, a163
    v_mul_f32 v72, v72, v12
    v_mul_f32 v73, v73, v12
    v_mfma_f32_16x16x32_bf16 v[216:219], v[184:187], v[24:27], v[216:219]
    v_mul_f32 v74, v74, v12
    v_mul_f32 v75, v75, v12
    v_cvt_pk_bf16_f32 v104, v72, v73
    v_cvt_pk_bf16_f32 v105, v74, v75
    v_mfma_f32_16x16x32_bf16 v[216:219], v[188:191], v[28:31], v[216:219]
    ds_write_b64 v18, v[104:105] offset:4608
    v_accvgpr_read_b32 v76, a164
    v_accvgpr_read_b32 v77, a165
    v_mfma_f32_16x16x32_bf16 a[120:123], v[176:179], v[128:131], a[120:123]
    v_accvgpr_read_b32 v78, a166
    v_accvgpr_read_b32 v79, a167
    v_mul_f32 v76, v76, v12
    v_mfma_f32_16x16x32_bf16 a[120:123], v[180:183], v[132:135], a[120:123]
    s_waitcnt lgkmcnt(3)
    buffer_store_dwordx4 v[48:51], v20, s[16:19], s54 offen offset:0 nt
    s_waitcnt lgkmcnt(2)
    buffer_store_dwordx4 v[52:55], v20, s[16:19], s55 offen offset:0 nt
    v_mul_f32 v77, v77, v12
    v_mul_f32 v78, v78, v12
    v_mfma_f32_16x16x32_bf16 a[120:123], v[184:187], v[40:43], a[120:123]
    ds_read_b64_tr_b16 v[144:145], v2 offset:256
    v_mul_f32 v79, v79, v12
    v_cvt_pk_bf16_f32 v106, v76, v77
    v_cvt_pk_bf16_f32 v107, v78, v79
    v_mfma_f32_16x16x32_bf16 a[120:123], v[188:191], v[44:47], a[120:123]
    ds_write_b64 v18, v[106:107] offset:4640
    ds_read_b64_tr_b16 v[146:147], v2 offset:1296
    v_accvgpr_read_b32 v80, a168
    v_mfma_f32_16x16x32_bf16 a[184:187], v[176:179], v[136:139], a[184:187]
    ds_read_b64_tr_b16 v[148:149], v2 offset:16896
    ds_read_b64_tr_b16 v[150:151], v2 offset:17936
    v_accvgpr_read_b32 v81, a169
    v_accvgpr_read_b32 v82, a170
    v_mfma_f32_16x16x32_bf16 a[184:187], v[180:183], v[140:143], a[184:187]
    ds_read_b64_tr_b16 v[152:153], v2 offset:33536
    v_accvgpr_read_b32 v83, a171
    v_mul_f32 v80, v80, v12
    v_mul_f32 v81, v81, v12
    v_mfma_f32_16x16x32_bf16 a[184:187], v[184:187], v[56:59], a[184:187]
    ds_read_b64_tr_b16 v[154:155], v2 offset:34576
    ds_read_b64_tr_b16 v[156:157], v2 offset:50176
    v_mul_f32 v82, v82, v12
    v_mul_f32 v83, v83, v12
    v_mfma_f32_16x16x32_bf16 a[184:187], v[188:191], v[60:63], a[184:187]
    ds_read_b64_tr_b16 v[158:159], v2 offset:51216
    v_cvt_pk_bf16_f32 v108, v80, v81
    v_cvt_pk_bf16_f32 v109, v82, v83
    s_waitcnt lgkmcnt(10)
    v_mfma_f32_16x16x32_bf16 v[220:223], a[240:243], v[120:123], v[220:223]
    ds_write_b64 v18, v[108:109] offset:4672
    v_accvgpr_read_b32 v84, a172
    v_accvgpr_read_b32 v85, a173
    v_mfma_f32_16x16x32_bf16 v[220:223], a[244:247], v[124:127], v[220:223]
    v_accvgpr_read_b32 v86, a174
    v_accvgpr_read_b32 v87, a175
    v_mul_f32 v84, v84, v12
    v_mul_f32 v85, v85, v12
    v_mfma_f32_16x16x32_bf16 v[220:223], a[248:251], v[24:27], v[220:223]
    v_mul_f32 v86, v86, v12
    v_mul_f32 v87, v87, v12
    v_cvt_pk_bf16_f32 v110, v84, v85
    v_cvt_pk_bf16_f32 v111, v86, v87
    v_mfma_f32_16x16x32_bf16 v[220:223], a[252:255], v[28:31], v[220:223]
    ds_write_b64 v18, v[110:111] offset:4704
    ds_read_b128 v[64:67], v19 offset:4608
    ds_read_b128 v[68:71], v19 offset:5760
    v_mfma_f32_16x16x32_bf16 a[124:127], a[240:243], v[128:131], a[124:127]
    ds_read_b64_tr_b16 v[160:161], v2 offset:288
    ds_read_b64_tr_b16 v[162:163], v2 offset:1328
    ds_read_b64_tr_b16 v[164:165], v2 offset:16928
    ds_read_b64_tr_b16 v[166:167], v2 offset:17968
    v_mfma_f32_16x16x32_bf16 a[124:127], a[244:247], v[132:135], a[124:127]
    ds_read_b64_tr_b16 v[168:169], v2 offset:33568
    ds_read_b64_tr_b16 v[170:171], v2 offset:34608
    ds_read_b64_tr_b16 v[172:173], v2 offset:50208
    ds_read_b64_tr_b16 v[174:175], v2 offset:51248
    v_mfma_f32_16x16x32_bf16 a[124:127], a[248:251], v[40:43], a[124:127]
    v_mfma_f32_16x16x32_bf16 a[124:127], a[252:255], v[44:47], a[124:127]
    v_mul_f32 v208, v208, v10
    v_mul_f32 v209, v209, v10
    v_mul_f32 v210, v210, v10
    v_mul_f32 v211, v211, v10
    v_mfma_f32_16x16x32_bf16 a[188:191], a[240:243], v[136:139], a[188:191]
    v_cvt_pk_bf16_f32 v112, v208, v209
    v_cvt_pk_bf16_f32 v113, v210, v211
    v_mfma_f32_16x16x32_bf16 a[188:191], a[244:247], v[140:143], a[188:191]
    ds_write_b64 v18, v[112:113] offset:6912
    v_mul_f32 v212, v212, v10
    v_mul_f32 v213, v213, v10
    v_mfma_f32_16x16x32_bf16 a[188:191], a[248:251], v[56:59], a[188:191]
    v_mul_f32 v214, v214, v10
    v_mul_f32 v215, v215, v10
    v_cvt_pk_bf16_f32 v114, v212, v213
    v_cvt_pk_bf16_f32 v115, v214, v215
    v_mfma_f32_16x16x32_bf16 a[188:191], a[252:255], v[60:63], a[188:191]
    ds_write_b64 v18, v[114:115] offset:6944
    v_mul_f32 v216, v216, v10
    s_waitcnt lgkmcnt(14)
    v_mfma_f32_16x16x32_bf16 v[224:227], v[144:147], v[120:123], v[224:227]
    v_mul_f32 v217, v217, v10
    v_mfma_f32_16x16x32_bf16 v[224:227], v[148:151], v[124:127], v[224:227]
    s_waitcnt lgkmcnt(11)
    buffer_store_dwordx4 v[64:67], v20, s[16:19], s56 offen offset:0 nt
    s_waitcnt lgkmcnt(10)
    buffer_store_dwordx4 v[68:71], v20, s[16:19], s57 offen offset:0 nt
    v_mul_f32 v218, v218, v10
    v_mul_f32 v219, v219, v10
    v_mfma_f32_16x16x32_bf16 v[224:227], v[152:155], v[24:27], v[224:227]
    v_cvt_pk_bf16_f32 v116, v216, v217
    v_cvt_pk_bf16_f32 v117, v218, v219
    v_mfma_f32_16x16x32_bf16 v[224:227], v[156:159], v[28:31], v[224:227]
    ds_write_b64 v18, v[116:117] offset:6976
    v_mul_f32 v220, v220, v10
    v_mul_f32 v221, v221, v10
    v_mfma_f32_16x16x32_bf16 a[128:131], v[144:147], v[128:131], a[128:131]
    v_mul_f32 v222, v222, v10
    v_mul_f32 v223, v223, v10
    v_cvt_pk_bf16_f32 v118, v220, v221
    v_cvt_pk_bf16_f32 v119, v222, v223
    v_mfma_f32_16x16x32_bf16 a[128:131], v[148:151], v[132:135], a[128:131]
    ds_write_b64 v18, v[118:119] offset:7008
    ds_read_b128 v[32:35], v19 offset:6912
    ds_read_b128 v[36:39], v19 offset:8064
    v_mfma_f32_16x16x32_bf16 a[128:131], v[152:155], v[40:43], a[128:131]
    ds_read_b64_tr_b16 v[176:177], v2 offset:320
    v_accvgpr_read_b32 v72, a112
    v_accvgpr_read_b32 v73, a113
    v_accvgpr_read_b32 v74, a114
    v_mfma_f32_16x16x32_bf16 a[128:131], v[156:159], v[44:47], a[128:131]
    ds_read_b64_tr_b16 v[178:179], v2 offset:1360
    v_accvgpr_read_b32 v75, a115
    v_mul_f32 v72, v72, v11
    v_mul_f32 v73, v73, v11
    v_mfma_f32_16x16x32_bf16 a[192:195], v[144:147], v[136:139], a[192:195]
    ds_read_b64_tr_b16 v[180:181], v2 offset:16960
    ds_read_b64_tr_b16 v[182:183], v2 offset:18000
    v_mul_f32 v74, v74, v11
    v_mul_f32 v75, v75, v11
    v_mfma_f32_16x16x32_bf16 a[192:195], v[148:151], v[140:143], a[192:195]
    ds_read_b64_tr_b16 v[184:185], v2 offset:33600
    v_cvt_pk_bf16_f32 v104, v72, v73
    v_cvt_pk_bf16_f32 v105, v74, v75
    v_mfma_f32_16x16x32_bf16 a[192:195], v[152:155], v[56:59], a[192:195]
    ds_write_b64 v18, v[104:105] offset:0
    ds_read_b64_tr_b16 v[186:187], v2 offset:34640
    ds_read_b64_tr_b16 v[188:189], v2 offset:50240
    v_mfma_f32_16x16x32_bf16 a[192:195], v[156:159], v[60:63], a[192:195]
    ds_read_b64_tr_b16 v[190:191], v2 offset:51280
    v_accvgpr_read_b32 v76, a116
    v_accvgpr_read_b32 v77, a117
    s_waitcnt lgkmcnt(15)
    v_mfma_f32_16x16x32_bf16 v[228:231], v[160:163], v[120:123], v[228:231]
    v_accvgpr_read_b32 v78, a118
    v_accvgpr_read_b32 v79, a119
    v_mul_f32 v76, v76, v11
    v_mfma_f32_16x16x32_bf16 v[228:231], v[164:167], v[124:127], v[228:231]
    s_waitcnt lgkmcnt(10)
    buffer_store_dwordx4 v[32:35], v20, s[16:19], s52 offen offset:128 nt
    s_waitcnt lgkmcnt(9)
    buffer_store_dwordx4 v[36:39], v20, s[16:19], s53 offen offset:128 nt
    v_mul_f32 v77, v77, v11
    v_mul_f32 v78, v78, v11
    v_mfma_f32_16x16x32_bf16 v[228:231], v[168:171], v[24:27], v[228:231]
    v_mul_f32 v79, v79, v11
    v_cvt_pk_bf16_f32 v106, v76, v77
    v_cvt_pk_bf16_f32 v107, v78, v79
    v_mfma_f32_16x16x32_bf16 v[228:231], v[172:175], v[28:31], v[228:231]
    ds_write_b64 v18, v[106:107] offset:32
    v_accvgpr_read_b32 v80, a120
    v_accvgpr_read_b32 v81, a121
    v_mfma_f32_16x16x32_bf16 a[132:135], v[160:163], v[128:131], a[132:135]
    v_accvgpr_read_b32 v82, a122
    v_accvgpr_read_b32 v83, a123
    v_mul_f32 v80, v80, v11
    v_mul_f32 v81, v81, v11
    v_mfma_f32_16x16x32_bf16 a[132:135], v[164:167], v[132:135], a[132:135]
    v_mul_f32 v82, v82, v11
    v_mul_f32 v83, v83, v11
    v_cvt_pk_bf16_f32 v108, v80, v81
    v_cvt_pk_bf16_f32 v109, v82, v83
    v_mfma_f32_16x16x32_bf16 a[132:135], v[168:171], v[40:43], a[132:135]
    ds_write_b64 v18, v[108:109] offset:64
    ds_read_b64_tr_b16 a[240:241], v2 offset:352
    v_accvgpr_read_b32 v84, a124
    v_mfma_f32_16x16x32_bf16 a[132:135], v[172:175], v[44:47], a[132:135]
    ds_read_b64_tr_b16 a[242:243], v2 offset:1392
    v_accvgpr_read_b32 v85, a125
    v_accvgpr_read_b32 v86, a126
    v_accvgpr_read_b32 v87, a127
    v_mfma_f32_16x16x32_bf16 a[196:199], v[160:163], v[136:139], a[196:199]
    ds_read_b64_tr_b16 a[244:245], v2 offset:16992
    ds_read_b64_tr_b16 a[246:247], v2 offset:18032
    v_mul_f32 v84, v84, v11
    v_mul_f32 v85, v85, v11
    v_mfma_f32_16x16x32_bf16 a[196:199], v[164:167], v[140:143], a[196:199]
    ds_read_b64_tr_b16 a[248:249], v2 offset:33632
    v_mul_f32 v86, v86, v11
    v_mul_f32 v87, v87, v11
    v_cvt_pk_bf16_f32 v110, v84, v85
    v_mfma_f32_16x16x32_bf16 a[196:199], v[168:171], v[56:59], a[196:199]
    ds_read_b64_tr_b16 a[250:251], v2 offset:34672
    ds_read_b64_tr_b16 a[252:253], v2 offset:50272
    v_cvt_pk_bf16_f32 v111, v86, v87
    v_mfma_f32_16x16x32_bf16 a[196:199], v[172:175], v[60:63], a[196:199]
    ds_write_b64 v18, v[110:111] offset:96
    ds_read_b128 v[48:51], v19 offset:0
    s_waitcnt lgkmcnt(11)
    v_mfma_f32_16x16x32_bf16 v[232:235], v[176:179], v[120:123], v[232:235]
    ds_read_b128 v[52:55], v19 offset:1152
    ds_read_b64_tr_b16 a[254:255], v2 offset:51312
    v_accvgpr_read_b32 v88, a176
    v_accvgpr_read_b32 v89, a177
    v_mfma_f32_16x16x32_bf16 v[232:235], v[180:183], v[124:127], v[232:235]
    v_accvgpr_read_b32 v90, a178
    v_accvgpr_read_b32 v91, a179
    v_mul_f32 v88, v88, v12
    v_mul_f32 v89, v89, v12
    v_mfma_f32_16x16x32_bf16 v[232:235], v[184:187], v[24:27], v[232:235]
    v_mul_f32 v90, v90, v12
    v_mul_f32 v91, v91, v12
    v_cvt_pk_bf16_f32 v112, v88, v89
    v_cvt_pk_bf16_f32 v113, v90, v91
    v_mfma_f32_16x16x32_bf16 v[232:235], v[188:191], v[28:31], v[232:235]
    ds_write_b64 v18, v[112:113] offset:2304
    v_accvgpr_read_b32 v92, a180
    v_accvgpr_read_b32 v93, a181
    v_mfma_f32_16x16x32_bf16 a[136:139], v[176:179], v[128:131], a[136:139]
    v_accvgpr_read_b32 v94, a182
    v_accvgpr_read_b32 v95, a183
    v_mul_f32 v92, v92, v12
    v_mfma_f32_16x16x32_bf16 a[136:139], v[180:183], v[132:135], a[136:139]
    s_waitcnt lgkmcnt(3)
    buffer_store_dwordx4 v[48:51], v20, s[16:19], s54 offen offset:128 nt
    s_waitcnt lgkmcnt(2)
    buffer_store_dwordx4 v[52:55], v20, s[16:19], s55 offen offset:128 nt
    v_mul_f32 v93, v93, v12
    v_mul_f32 v94, v94, v12
    v_mfma_f32_16x16x32_bf16 a[136:139], v[184:187], v[40:43], a[136:139]
    ds_read_b64_tr_b16 v[144:145], v2 offset:384
    v_mul_f32 v95, v95, v12
    v_cvt_pk_bf16_f32 v114, v92, v93
    v_cvt_pk_bf16_f32 v115, v94, v95
    v_mfma_f32_16x16x32_bf16 a[136:139], v[188:191], v[44:47], a[136:139]
    ds_write_b64 v18, v[114:115] offset:2336
    ds_read_b64_tr_b16 v[146:147], v2 offset:1424
    v_accvgpr_read_b32 v96, a184
    v_mfma_f32_16x16x32_bf16 a[200:203], v[176:179], v[136:139], a[200:203]
    ds_read_b64_tr_b16 v[148:149], v2 offset:17024
    ds_read_b64_tr_b16 v[150:151], v2 offset:18064
    v_accvgpr_read_b32 v97, a185
    v_accvgpr_read_b32 v98, a186
    v_mfma_f32_16x16x32_bf16 a[200:203], v[180:183], v[140:143], a[200:203]
    ds_read_b64_tr_b16 v[152:153], v2 offset:33664
    v_accvgpr_read_b32 v99, a187
    v_mul_f32 v96, v96, v12
    v_mul_f32 v97, v97, v12
    v_mfma_f32_16x16x32_bf16 a[200:203], v[184:187], v[56:59], a[200:203]
    ds_read_b64_tr_b16 v[154:155], v2 offset:34704
    ds_read_b64_tr_b16 v[156:157], v2 offset:50304
    v_mul_f32 v98, v98, v12
    v_mul_f32 v99, v99, v12
    v_mfma_f32_16x16x32_bf16 a[200:203], v[188:191], v[60:63], a[200:203]
    ds_read_b64_tr_b16 v[158:159], v2 offset:51344
    v_cvt_pk_bf16_f32 v116, v96, v97
    v_cvt_pk_bf16_f32 v117, v98, v99
    s_waitcnt lgkmcnt(10)
    v_mfma_f32_16x16x32_bf16 v[236:239], a[240:243], v[120:123], v[236:239]
    ds_write_b64 v18, v[116:117] offset:2368
    v_accvgpr_read_b32 v100, a188
    v_accvgpr_read_b32 v101, a189
    v_mfma_f32_16x16x32_bf16 v[236:239], a[244:247], v[124:127], v[236:239]
    v_accvgpr_read_b32 v102, a190
    v_accvgpr_read_b32 v103, a191
    v_mul_f32 v100, v100, v12
    v_mul_f32 v101, v101, v12
    v_mfma_f32_16x16x32_bf16 v[236:239], a[248:251], v[24:27], v[236:239]
    v_mul_f32 v102, v102, v12
    v_mul_f32 v103, v103, v12
    v_cvt_pk_bf16_f32 v118, v100, v101
    v_cvt_pk_bf16_f32 v119, v102, v103
    v_mfma_f32_16x16x32_bf16 v[236:239], a[252:255], v[28:31], v[236:239]
    ds_write_b64 v18, v[118:119] offset:2400
    ds_read_b128 v[64:67], v19 offset:2304
    ds_read_b128 v[68:71], v19 offset:3456
    v_mfma_f32_16x16x32_bf16 a[140:143], a[240:243], v[128:131], a[140:143]
    ds_read_b64_tr_b16 v[160:161], v2 offset:416
    ds_read_b64_tr_b16 v[162:163], v2 offset:1456
    ds_read_b64_tr_b16 v[164:165], v2 offset:17056
    ds_read_b64_tr_b16 v[166:167], v2 offset:18096
    v_mfma_f32_16x16x32_bf16 a[140:143], a[244:247], v[132:135], a[140:143]
    ds_read_b64_tr_b16 v[168:169], v2 offset:33696
    ds_read_b64_tr_b16 v[170:171], v2 offset:34736
    ds_read_b64_tr_b16 v[172:173], v2 offset:50336
    ds_read_b64_tr_b16 v[174:175], v2 offset:51376
    v_mfma_f32_16x16x32_bf16 a[140:143], a[248:251], v[40:43], a[140:143]
    v_mfma_f32_16x16x32_bf16 a[140:143], a[252:255], v[44:47], a[140:143]
    v_mul_f32 v224, v224, v10
    v_mul_f32 v225, v225, v10
    v_mul_f32 v226, v226, v10
    v_mul_f32 v227, v227, v10
    v_mfma_f32_16x16x32_bf16 a[204:207], a[240:243], v[136:139], a[204:207]
    v_cvt_pk_bf16_f32 v104, v224, v225
    v_cvt_pk_bf16_f32 v105, v226, v227
    v_mfma_f32_16x16x32_bf16 a[204:207], a[244:247], v[140:143], a[204:207]
    ds_write_b64 v18, v[104:105] offset:4608
    v_mul_f32 v228, v228, v10
    v_mul_f32 v229, v229, v10
    v_mfma_f32_16x16x32_bf16 a[204:207], a[248:251], v[56:59], a[204:207]
    v_mul_f32 v230, v230, v10
    v_mul_f32 v231, v231, v10
    v_cvt_pk_bf16_f32 v106, v228, v229
    v_cvt_pk_bf16_f32 v107, v230, v231
    v_mfma_f32_16x16x32_bf16 a[204:207], a[252:255], v[60:63], a[204:207]
    ds_write_b64 v18, v[106:107] offset:4640
    v_mul_f32 v232, v232, v10
    s_waitcnt lgkmcnt(14)
    v_mfma_f32_16x16x32_bf16 v[240:243], v[144:147], v[120:123], v[240:243]
    v_mul_f32 v233, v233, v10
    v_mfma_f32_16x16x32_bf16 v[240:243], v[148:151], v[124:127], v[240:243]
    s_waitcnt lgkmcnt(11)
    buffer_store_dwordx4 v[64:67], v20, s[16:19], s56 offen offset:128 nt
    s_waitcnt lgkmcnt(10)
    buffer_store_dwordx4 v[68:71], v20, s[16:19], s57 offen offset:128 nt
    v_mul_f32 v234, v234, v10
    v_mul_f32 v235, v235, v10
    v_mfma_f32_16x16x32_bf16 v[240:243], v[152:155], v[24:27], v[240:243]
    v_cvt_pk_bf16_f32 v108, v232, v233
    v_cvt_pk_bf16_f32 v109, v234, v235
    v_mfma_f32_16x16x32_bf16 v[240:243], v[156:159], v[28:31], v[240:243]
    ds_write_b64 v18, v[108:109] offset:4672
    v_mul_f32 v236, v236, v10
    v_mul_f32 v237, v237, v10
    v_mfma_f32_16x16x32_bf16 a[144:147], v[144:147], v[128:131], a[144:147]
    v_mul_f32 v238, v238, v10
    v_mul_f32 v239, v239, v10
    v_cvt_pk_bf16_f32 v110, v236, v237
    v_cvt_pk_bf16_f32 v111, v238, v239
    v_mfma_f32_16x16x32_bf16 a[144:147], v[148:151], v[132:135], a[144:147]
    ds_write_b64 v18, v[110:111] offset:4704
    ds_read_b128 v[32:35], v19 offset:4608
    ds_read_b128 v[36:39], v19 offset:5760
    v_mfma_f32_16x16x32_bf16 a[144:147], v[152:155], v[40:43], a[144:147]
    ds_read_b64_tr_b16 v[176:177], v2 offset:448
    v_accvgpr_read_b32 v88, a128
    v_accvgpr_read_b32 v89, a129
    v_accvgpr_read_b32 v90, a130
    v_mfma_f32_16x16x32_bf16 a[144:147], v[156:159], v[44:47], a[144:147]
    ds_read_b64_tr_b16 v[178:179], v2 offset:1488
    v_accvgpr_read_b32 v91, a131
    v_mul_f32 v88, v88, v11
    v_mul_f32 v89, v89, v11
    v_mfma_f32_16x16x32_bf16 a[208:211], v[144:147], v[136:139], a[208:211]
    ds_read_b64_tr_b16 v[180:181], v2 offset:17088
    ds_read_b64_tr_b16 v[182:183], v2 offset:18128
    v_mul_f32 v90, v90, v11
    v_mul_f32 v91, v91, v11
    v_mfma_f32_16x16x32_bf16 a[208:211], v[148:151], v[140:143], a[208:211]
    ds_read_b64_tr_b16 v[184:185], v2 offset:33728
    v_cvt_pk_bf16_f32 v112, v88, v89
    v_cvt_pk_bf16_f32 v113, v90, v91
    v_mfma_f32_16x16x32_bf16 a[208:211], v[152:155], v[56:59], a[208:211]
    ds_write_b64 v18, v[112:113] offset:6912
    ds_read_b64_tr_b16 v[186:187], v2 offset:34768
    ds_read_b64_tr_b16 v[188:189], v2 offset:50368
    v_mfma_f32_16x16x32_bf16 a[208:211], v[156:159], v[60:63], a[208:211]
    ds_read_b64_tr_b16 v[190:191], v2 offset:51408
    v_accvgpr_read_b32 v92, a132
    v_accvgpr_read_b32 v93, a133
    s_waitcnt lgkmcnt(15)
    v_mfma_f32_16x16x32_bf16 v[244:247], v[160:163], v[120:123], v[244:247]
    v_accvgpr_read_b32 v94, a134
    v_accvgpr_read_b32 v95, a135
    v_mul_f32 v92, v92, v11
    v_mfma_f32_16x16x32_bf16 v[244:247], v[164:167], v[124:127], v[244:247]
    s_waitcnt lgkmcnt(10)
    buffer_store_dwordx4 v[32:35], v20, s[16:19], s52 offen offset:256 nt
    s_waitcnt lgkmcnt(9)
    buffer_store_dwordx4 v[36:39], v20, s[16:19], s53 offen offset:256 nt
    v_mul_f32 v93, v93, v11
    v_mul_f32 v94, v94, v11
    v_mfma_f32_16x16x32_bf16 v[244:247], v[168:171], v[24:27], v[244:247]
    v_mul_f32 v95, v95, v11
    v_cvt_pk_bf16_f32 v114, v92, v93
    v_cvt_pk_bf16_f32 v115, v94, v95
    v_mfma_f32_16x16x32_bf16 v[244:247], v[172:175], v[28:31], v[244:247]
    ds_write_b64 v18, v[114:115] offset:6944
    v_accvgpr_read_b32 v96, a136
    v_accvgpr_read_b32 v97, a137
    v_mfma_f32_16x16x32_bf16 a[148:151], v[160:163], v[128:131], a[148:151]
    v_accvgpr_read_b32 v98, a138
    v_accvgpr_read_b32 v99, a139
    v_mul_f32 v96, v96, v11
    v_mul_f32 v97, v97, v11
    v_mfma_f32_16x16x32_bf16 a[148:151], v[164:167], v[132:135], a[148:151]
    v_mul_f32 v98, v98, v11
    v_mul_f32 v99, v99, v11
    v_cvt_pk_bf16_f32 v116, v96, v97
    v_cvt_pk_bf16_f32 v117, v98, v99
    v_mfma_f32_16x16x32_bf16 a[148:151], v[168:171], v[40:43], a[148:151]
    ds_write_b64 v18, v[116:117] offset:6976
    ds_read_b64_tr_b16 a[240:241], v2 offset:480
    v_accvgpr_read_b32 v100, a140
    v_mfma_f32_16x16x32_bf16 a[148:151], v[172:175], v[44:47], a[148:151]
    ds_read_b64_tr_b16 a[242:243], v2 offset:1520
    v_accvgpr_read_b32 v101, a141
    v_accvgpr_read_b32 v102, a142
    v_accvgpr_read_b32 v103, a143
    v_mfma_f32_16x16x32_bf16 a[212:215], v[160:163], v[136:139], a[212:215]
    ds_read_b64_tr_b16 a[244:245], v2 offset:17120
    ds_read_b64_tr_b16 a[246:247], v2 offset:18160
    v_mul_f32 v100, v100, v11
    v_mul_f32 v101, v101, v11
    v_mfma_f32_16x16x32_bf16 a[212:215], v[164:167], v[140:143], a[212:215]
    ds_read_b64_tr_b16 a[248:249], v2 offset:33760
    v_mul_f32 v102, v102, v11
    v_mul_f32 v103, v103, v11
    v_cvt_pk_bf16_f32 v118, v100, v101
    v_mfma_f32_16x16x32_bf16 a[212:215], v[168:171], v[56:59], a[212:215]
    ds_read_b64_tr_b16 a[250:251], v2 offset:34800
    ds_read_b64_tr_b16 a[252:253], v2 offset:50400
    v_cvt_pk_bf16_f32 v119, v102, v103
    v_mfma_f32_16x16x32_bf16 a[212:215], v[172:175], v[60:63], a[212:215]
    ds_write_b64 v18, v[118:119] offset:7008
    ds_read_b128 v[48:51], v19 offset:6912
    s_waitcnt lgkmcnt(11)
    v_mfma_f32_16x16x32_bf16 v[248:251], v[176:179], v[120:123], v[248:251]
    ds_read_b128 v[52:55], v19 offset:8064
    ds_read_b64_tr_b16 a[254:255], v2 offset:51440
    v_accvgpr_read_b32 v72, a192
    v_accvgpr_read_b32 v73, a193
    v_mfma_f32_16x16x32_bf16 v[248:251], v[180:183], v[124:127], v[248:251]
    v_accvgpr_read_b32 v74, a194
    v_accvgpr_read_b32 v75, a195
    v_mul_f32 v72, v72, v12
    v_mul_f32 v73, v73, v12
    v_mfma_f32_16x16x32_bf16 v[248:251], v[184:187], v[24:27], v[248:251]
    v_mul_f32 v74, v74, v12
    v_mul_f32 v75, v75, v12
    v_cvt_pk_bf16_f32 v104, v72, v73
    v_cvt_pk_bf16_f32 v105, v74, v75
    v_mfma_f32_16x16x32_bf16 v[248:251], v[188:191], v[28:31], v[248:251]
    ds_write_b64 v18, v[104:105] offset:0
    v_accvgpr_read_b32 v76, a196
    v_accvgpr_read_b32 v77, a197
    v_mfma_f32_16x16x32_bf16 a[152:155], v[176:179], v[128:131], a[152:155]
    v_accvgpr_read_b32 v78, a198
    v_accvgpr_read_b32 v79, a199
    v_mul_f32 v76, v76, v12
    v_mfma_f32_16x16x32_bf16 a[152:155], v[180:183], v[132:135], a[152:155]
    s_waitcnt lgkmcnt(3)
    buffer_store_dwordx4 v[48:51], v20, s[16:19], s54 offen offset:256 nt
    s_waitcnt lgkmcnt(2)
    buffer_store_dwordx4 v[52:55], v20, s[16:19], s55 offen offset:256 nt
    v_mul_f32 v77, v77, v12
    v_mul_f32 v78, v78, v12
    v_mfma_f32_16x16x32_bf16 a[152:155], v[184:187], v[40:43], a[152:155]
    v_mul_f32 v79, v79, v12
    v_cvt_pk_bf16_f32 v106, v76, v77
    v_cvt_pk_bf16_f32 v107, v78, v79
    v_mfma_f32_16x16x32_bf16 a[152:155], v[188:191], v[44:47], a[152:155]
    ds_write_b64 v18, v[106:107] offset:32
    v_accvgpr_read_b32 v80, a200
    v_accvgpr_read_b32 v81, a201
    v_mfma_f32_16x16x32_bf16 a[216:219], v[176:179], v[136:139], a[216:219]
    v_accvgpr_read_b32 v82, a202
    v_accvgpr_read_b32 v83, a203
    v_mul_f32 v80, v80, v12
    v_mul_f32 v81, v81, v12
    v_mfma_f32_16x16x32_bf16 a[216:219], v[180:183], v[140:143], a[216:219]
    v_mul_f32 v82, v82, v12
    v_mul_f32 v83, v83, v12
    v_cvt_pk_bf16_f32 v108, v80, v81
    v_cvt_pk_bf16_f32 v109, v82, v83
    v_mfma_f32_16x16x32_bf16 a[216:219], v[184:187], v[56:59], a[216:219]
    ds_write_b64 v18, v[108:109] offset:64
    v_accvgpr_read_b32 v84, a204
    v_accvgpr_read_b32 v85, a205
    v_mfma_f32_16x16x32_bf16 a[216:219], v[188:191], v[60:63], a[216:219]
    v_accvgpr_read_b32 v86, a206
    v_accvgpr_read_b32 v87, a207
    v_mul_f32 v84, v84, v12
    s_waitcnt lgkmcnt(3)
    v_mfma_f32_16x16x32_bf16 v[252:255], a[240:243], v[120:123], v[252:255]
    v_mul_f32 v85, v85, v12
    v_mul_f32 v86, v86, v12
    v_mul_f32 v87, v87, v12
    v_cvt_pk_bf16_f32 v110, v84, v85
    v_mfma_f32_16x16x32_bf16 v[252:255], a[244:247], v[124:127], v[252:255]
    v_cvt_pk_bf16_f32 v111, v86, v87
    v_mfma_f32_16x16x32_bf16 v[252:255], a[248:251], v[24:27], v[252:255]
    ds_write_b64 v18, v[110:111] offset:96
    ds_read_b128 v[64:67], v19 offset:0
    ds_read_b128 v[68:71], v19 offset:1152
    v_mfma_f32_16x16x32_bf16 v[252:255], a[252:255], v[28:31], v[252:255]
    v_mfma_f32_16x16x32_bf16 a[156:159], a[240:243], v[128:131], a[156:159]
    v_mfma_f32_16x16x32_bf16 a[156:159], a[244:247], v[132:135], a[156:159]
    v_mfma_f32_16x16x32_bf16 a[156:159], a[248:251], v[40:43], a[156:159]
    v_mfma_f32_16x16x32_bf16 a[156:159], a[252:255], v[44:47], a[156:159]
    v_mul_f32 v240, v240, v10
    v_mul_f32 v241, v241, v10
    v_mul_f32 v242, v242, v10
    v_mul_f32 v243, v243, v10
    v_mfma_f32_16x16x32_bf16 a[220:223], a[240:243], v[136:139], a[220:223]
    v_cvt_pk_bf16_f32 v112, v240, v241
    v_cvt_pk_bf16_f32 v113, v242, v243
    v_mfma_f32_16x16x32_bf16 a[220:223], a[244:247], v[140:143], a[220:223]
    ds_write_b64 v18, v[112:113] offset:2304
    v_mul_f32 v244, v244, v10
    v_mul_f32 v245, v245, v10
    v_mfma_f32_16x16x32_bf16 a[220:223], a[248:251], v[56:59], a[220:223]
    v_mul_f32 v246, v246, v10
    v_mul_f32 v247, v247, v10
    v_cvt_pk_bf16_f32 v114, v244, v245
    v_cvt_pk_bf16_f32 v115, v246, v247
    v_mfma_f32_16x16x32_bf16 a[220:223], a[252:255], v[60:63], a[220:223]
    ds_write_b64 v18, v[114:115] offset:2336
    v_mul_f32 v248, v248, v10
    v_mul_f32 v249, v249, v10
    s_waitcnt lgkmcnt(3)
    buffer_store_dwordx4 v[64:67], v20, s[16:19], s56 offen offset:256 nt
    s_waitcnt lgkmcnt(2)
    buffer_store_dwordx4 v[68:71], v20, s[16:19], s57 offen offset:256 nt
    v_mul_f32 v250, v250, v10
    v_mul_f32 v251, v251, v10
    v_cvt_pk_bf16_f32 v116, v248, v249
    v_cvt_pk_bf16_f32 v117, v250, v251
    ds_write_b64 v18, v[116:117] offset:2368
    v_mul_f32 v252, v252, v10
    v_mul_f32 v253, v253, v10
    v_mul_f32 v254, v254, v10
    v_mul_f32 v255, v255, v10
    v_cvt_pk_bf16_f32 v118, v252, v253
    v_cvt_pk_bf16_f32 v119, v254, v255
    ds_write_b64 v18, v[118:119] offset:2400
    ds_read_b128 v[32:35], v19 offset:2304
    ds_read_b128 v[36:39], v19 offset:3456
    v_accvgpr_read_b32 v72, a144
    v_accvgpr_read_b32 v73, a145
    v_accvgpr_read_b32 v74, a146
    v_accvgpr_read_b32 v75, a147
    v_mul_f32 v72, v72, v11
    v_mul_f32 v73, v73, v11
    v_mul_f32 v74, v74, v11
    v_mul_f32 v75, v75, v11
    v_cvt_pk_bf16_f32 v104, v72, v73
    v_cvt_pk_bf16_f32 v105, v74, v75
    ds_write_b64 v18, v[104:105] offset:4608
    v_accvgpr_read_b32 v76, a148
    v_accvgpr_read_b32 v77, a149
    v_accvgpr_read_b32 v78, a150
    v_accvgpr_read_b32 v79, a151
    v_mul_f32 v76, v76, v11
    s_waitcnt lgkmcnt(2)
    buffer_store_dwordx4 v[32:35], v20, s[16:19], s52 offen offset:384 nt
    s_waitcnt lgkmcnt(1)
    buffer_store_dwordx4 v[36:39], v20, s[16:19], s53 offen offset:384 nt
    v_mul_f32 v77, v77, v11
    v_mul_f32 v78, v78, v11
    v_mul_f32 v79, v79, v11
    v_cvt_pk_bf16_f32 v106, v76, v77
    v_cvt_pk_bf16_f32 v107, v78, v79
    ds_write_b64 v18, v[106:107] offset:4640
    v_accvgpr_read_b32 v80, a152
    v_accvgpr_read_b32 v81, a153
    v_accvgpr_read_b32 v82, a154
    v_accvgpr_read_b32 v83, a155
    v_mul_f32 v80, v80, v11
    v_mul_f32 v81, v81, v11
    v_mul_f32 v82, v82, v11
    v_mul_f32 v83, v83, v11
    v_cvt_pk_bf16_f32 v108, v80, v81
    v_cvt_pk_bf16_f32 v109, v82, v83
    ds_write_b64 v18, v[108:109] offset:4672
    v_accvgpr_read_b32 v84, a156
    v_accvgpr_read_b32 v85, a157
    v_accvgpr_read_b32 v86, a158
    v_accvgpr_read_b32 v87, a159
    v_mul_f32 v84, v84, v11
    v_mul_f32 v85, v85, v11
    v_mul_f32 v86, v86, v11
    v_mul_f32 v87, v87, v11
    v_cvt_pk_bf16_f32 v110, v84, v85
    v_cvt_pk_bf16_f32 v111, v86, v87
    ds_write_b64 v18, v[110:111] offset:4704
    ds_read_b128 v[48:51], v19 offset:4608
    ds_read_b128 v[52:55], v19 offset:5760
    v_accvgpr_read_b32 v88, a208
    v_accvgpr_read_b32 v89, a209
    v_accvgpr_read_b32 v90, a210
    v_accvgpr_read_b32 v91, a211
    v_mul_f32 v88, v88, v12
    v_mul_f32 v89, v89, v12
    v_mul_f32 v90, v90, v12
    v_mul_f32 v91, v91, v12
    v_cvt_pk_bf16_f32 v112, v88, v89
    v_cvt_pk_bf16_f32 v113, v90, v91
    ds_write_b64 v18, v[112:113] offset:6912
    v_accvgpr_read_b32 v92, a212
    v_accvgpr_read_b32 v93, a213
    v_accvgpr_read_b32 v94, a214
    v_accvgpr_read_b32 v95, a215
    v_mul_f32 v92, v92, v12
    s_waitcnt lgkmcnt(2)
    buffer_store_dwordx4 v[48:51], v20, s[16:19], s54 offen offset:384 nt
    s_waitcnt lgkmcnt(1)
    buffer_store_dwordx4 v[52:55], v20, s[16:19], s55 offen offset:384 nt
    v_mul_f32 v93, v93, v12
    v_mul_f32 v94, v94, v12
    v_mul_f32 v95, v95, v12
    v_cvt_pk_bf16_f32 v114, v92, v93
    v_cvt_pk_bf16_f32 v115, v94, v95
    ds_write_b64 v18, v[114:115] offset:6944
    v_accvgpr_read_b32 v96, a216
    v_accvgpr_read_b32 v97, a217
    v_accvgpr_read_b32 v98, a218
    v_accvgpr_read_b32 v99, a219
    v_mul_f32 v96, v96, v12
    v_mul_f32 v97, v97, v12
    v_mul_f32 v98, v98, v12
    v_mul_f32 v99, v99, v12
    v_cvt_pk_bf16_f32 v116, v96, v97
    v_cvt_pk_bf16_f32 v117, v98, v99
    ds_write_b64 v18, v[116:117] offset:6976
    v_accvgpr_read_b32 v100, a220
    v_accvgpr_read_b32 v101, a221
    v_accvgpr_read_b32 v102, a222
    v_accvgpr_read_b32 v103, a223
    v_mul_f32 v100, v100, v12
    v_mul_f32 v101, v101, v12
    v_mul_f32 v102, v102, v12
    v_mul_f32 v103, v103, v12
    v_cvt_pk_bf16_f32 v118, v100, v101
    v_cvt_pk_bf16_f32 v119, v102, v103
    ds_write_b64 v18, v[118:119] offset:7008
    ds_read_b128 v[64:67], v19 offset:6912
    ds_read_b128 v[68:71], v19 offset:8064
    s_waitcnt lgkmcnt(1)
    buffer_store_dwordx4 v[64:67], v20, s[16:19], s56 offen offset:384 nt
    s_waitcnt lgkmcnt(0)
    buffer_store_dwordx4 v[68:71], v20, s[16:19], s57 offen offset:384 nt
L_end:
    s_endpgm
L_rare1_p0:
    v_max3_f32 v14, v32, v33, v34
    v_max3_f32 v14, v14, v35, v36
    v_max3_f32 v14, v14, v37, v38
    v_max_f32 v14, v14, v39
    v_mov_b32 v15, v14
    s_nop 1
    v_permlane32_swap_b32 v15, v14
    s_nop 0
    v_max_f32 v14, v14, v15
    v_mov_b32 v15, v14
    s_nop 1
    v_permlane16_swap_b32 v15, v14
    s_nop 0
    v_max_f32 v14, v14, v15
    v_mul_f32 v14, 0xbdb8aa3b, v14
    v_sub_f32 v15, v7, v14
    v_cmp_lt_f32 vcc, 0x41000000, v15
    s_nop 1
    v_cndmask_b32 v14, v7, v14, vcc
    v_sub_f32 v15, v14, v7
    v_exp_f32 v15, v15
    v_mov_b32 v7, v14
    v_mul_f32 v10, v10, v15
    s_cmp_lg_u64 vcc, 0
    s_cselect_b32 s47, 1, 0
    s_or_b32 s27, s27, s47
    v_fma_f32 v80, v32, s20, v7
    v_fma_f32 v81, v33, s20, v7
    v_fma_f32 v82, v34, s20, v7
    v_fma_f32 v83, v35, s20, v7
    v_fma_f32 v84, v36, s20, v7
    v_fma_f32 v85, v37, s20, v7
    v_fma_f32 v86, v38, s20, v7
    v_fma_f32 v87, v39, s20, v7
    v_mul_f32 v72, v72, v15
    v_mul_f32 v73, v73, v15
    v_mul_f32 v74, v74, v15
    v_mul_f32 v75, v75, v15
    v_mul_f32 v76, v76, v15
    v_mul_f32 v77, v77, v15
    v_mul_f32 v78, v78, v15
    v_mul_f32 v79, v79, v15
    v_max3_f32 v14, v48, v49, v50
    v_max3_f32 v14, v14, v51, v52
    v_max3_f32 v14, v14, v53, v54
    v_max_f32 v14, v14, v55
    v_mov_b32 v15, v14
    s_nop 1
    v_permlane32_swap_b32 v15, v14
    s_nop 0
    v_max_f32 v14, v14, v15
    v_mov_b32 v15, v14
    s_nop 1
    v_permlane16_swap_b32 v15, v14
    s_nop 0
    v_max_f32 v14, v14, v15
    v_mul_f32 v14, 0xbdb8aa3b, v14
    v_sub_f32 v15, v8, v14
    v_cmp_lt_f32 vcc, 0x41000000, v15
    s_nop 1
    v_cndmask_b32 v14, v8, v14, vcc
    v_sub_f32 v15, v14, v8
    v_exp_f32 v15, v15
    v_mov_b32 v8, v14
    v_mul_f32 v11, v11, v15
    s_cmp_lg_u64 vcc, 0
    s_cselect_b32 s47, 2, 0
    s_or_b32 s27, s27, s47
    v_fma_f32 v96, v48, s20, v8
    v_fma_f32 v97, v49, s20, v8
    v_fma_f32 v98, v50, s20, v8
    v_fma_f32 v99, v51, s20, v8
    v_fma_f32 v100, v52, s20, v8
    v_fma_f32 v101, v53, s20, v8
    v_fma_f32 v102, v54, s20, v8
    v_fma_f32 v103, v55, s20, v8
    v_mul_f32 v88, v88, v15
    v_mul_f32 v89, v89, v15
    v_mul_f32 v90, v90, v15
    v_mul_f32 v91, v91, v15
    v_mul_f32 v92, v92, v15
    v_mul_f32 v93, v93, v15
    v_mul_f32 v94, v94, v15
    v_mul_f32 v95, v95, v15
    s_branch L_back1_p0
L_rare1_p1:
    v_max3_f32 v14, v64, v65, v66
    v_max3_f32 v14, v14, v67, v68
    v_max3_f32 v14, v14, v69, v70
    v_max_f32 v14, v14, v71
    v_mov_b32 v15, v14
    s_nop 1
    v_permlane32_swap_b32 v15, v14
    s_nop 0
    v_max_f32 v14, v14, v15
    v_mov_b32 v15, v14
    s_nop 1
    v_permlane16_swap_b32 v15, v14
    s_nop 0
    v_max_f32 v14, v14, v15
    v_mul_f32 v14, 0xbdb8aa3b, v14
    v_sub_f32 v15, v9, v14
    v_cmp_lt_f32 vcc, 0x41000000, v15
    s_nop 1
    v_cndmask_b32 v14, v9, v14, vcc
    v_sub_f32 v15, v14, v9
    v_exp_f32 v15, v15
    v_mov_b32 v9, v14
    v_mul_f32 v12, v12, v15
    s_cmp_lg_u64 vcc, 0
    s_cselect_b32 s47, 4, 0
    s_or_b32 s27, s27, s47
    v_fma_f32 v112, v64, s20, v9
    v_fma_f32 v113, v65, s20, v9
    v_fma_f32 v114, v66, s20, v9
    v_fma_f32 v115, v67, s20, v9
    v_fma_f32 v116, v68, s20, v9
    v_fma_f32 v117, v69, s20, v9
    v_fma_f32 v118, v70, s20, v9
    v_fma_f32 v119, v71, s20, v9
    v_mul_f32 v104, v104, v15
    v_mul_f32 v105, v105, v15
    v_mul_f32 v106, v106, v15
    v_mul_f32 v107, v107, v15
    v_mul_f32 v108, v108, v15
    v_mul_f32 v109, v109, v15
    v_mul_f32 v110, v110, v15
    v_mul_f32 v111, v111, v15
    s_branch L_back1_p1
L_rare0_l0:
    v_max3_f32 v14, v24, v25, v26
    v_max3_f32 v14, v14, v27, v28
    v_max3_f32 v14, v14, v29, v30
    v_max_f32 v14, v14, v31
    v_mov_b32 v15, v14
    s_nop 1
    v_permlane32_swap_b32 v15, v14
    s_nop 0
    v_max_f32 v14, v14, v15
    v_mov_b32 v15, v14
    s_nop 1
    v_permlane16_swap_b32 v15, v14
    s_nop 0
    v_max_f32 v14, v14, v15
    v_mul_f32 v14, 0xbdb8aa3b, v14
    v_sub_f32 v15, v7, v14
    v_cmp_lt_f32 vcc, 0x41000000, v15
    s_nop 1
    v_cndmask_b32 v14, v7, v14, vcc
    v_sub_f32 v15, v14, v7
    v_exp_f32 v15, v15
    v_mov_b32 v7, v14
    v_mul_f32 v10, v10, v15
    s_cmp_lg_u64 vcc, 0
    s_cselect_b32 s47, 1, 0
    s_or_b32 s27, s27, s47
    v_fma_f32 v72, v24, s20, v7
    v_fma_f32 v73, v25, s20, v7
    v_fma_f32 v74, v26, s20, v7
    v_fma_f32 v75, v27, s20, v7
    v_fma_f32 v76, v28, s20, v7
    v_fma_f32 v77, v29, s20, v7
    v_fma_f32 v78, v30, s20, v7
    v_fma_f32 v79, v31, s20, v7
    v_max3_f32 v14, v40, v41, v42
    v_max3_f32 v14, v14, v43, v44
    v_max3_f32 v14, v14, v45, v46
    v_max_f32 v14, v14, v47
    v_mov_b32 v15, v14
    s_nop 1
    v_permlane32_swap_b32 v15, v14
    s_nop 0
    v_max_f32 v14, v14, v15
    v_mov_b32 v15, v14
    s_nop 1
    v_permlane16_swap_b32 v15, v14
    s_nop 0
    v_max_f32 v14, v14, v15
    v_mul_f32 v14, 0xbdb8aa3b, v14
    v_sub_f32 v15, v8, v14
    v_cmp_lt_f32 vcc, 0x41000000, v15
    s_nop 1
    v_cndmask_b32 v14, v8, v14, vcc
    v_sub_f32 v15, v14, v8
    v_exp_f32 v15, v15
    v_mov_b32 v8, v14
    v_mul_f32 v11, v11, v15
    s_cmp_lg_u64 vcc, 0
    s_cselect_b32 s47, 2, 0
    s_or_b32 s27, s27, s47
    v_fma_f32 v88, v40, s20, v8
    v_fma_f32 v89, v41, s20, v8
    v_fma_f32 v90, v42, s20, v8
    v_fma_f32 v91, v43, s20, v8
    v_fma_f32 v92, v44, s20, v8
    v_fma_f32 v93, v45, s20, v8
    v_fma_f32 v94, v46, s20, v8
    v_fma_f32 v95, v47, s20, v8
    v_max3_f32 v14, v56, v57, v58
    v_max3_f32 v14, v14, v59, v60
    v_max3_f32 v14, v14, v61, v62
    v_max_f32 v14, v14, v63
    v_mov_b32 v15, v14
    s_nop 1
    v_permlane32_swap_b32 v15, v14
    s_nop 0
    v_max_f32 v14, v14, v15
    v_mov_b32 v15, v14
    s_nop 1
    v_permlane16_swap_b32 v15, v14
    s_nop 0
    v_max_f32 v14, v14, v15
    v_mul_f32 v14, 0xbdb8aa3b, v14
    v_sub_f32 v15, v9, v14
    v_cmp_lt_f32 vcc, 0x41000000, v15
    s_nop 1
    v_cndmask_b32 v14, v9, v14, vcc
    v_sub_f32 v15, v14, v9
    v_exp_f32 v15, v15
    v_mov_b32 v9, v14
    v_mul_f32 v12, v12, v15
    s_cmp_lg_u64 vcc, 0
    s_cselect_b32 s47, 4, 0
    s_or_b32 s27, s27, s47
    v_fma_f32 v104, v56, s20, v9
    v_fma_f32 v105, v57, s20, v9
    v_fma_f32 v106, v58, s20, v9
    v_fma_f32 v107, v59, s20, v9
    v_fma_f32 v108, v60, s20, v9
    v_fma_f32 v109, v61, s20, v9
    v_fma_f32 v110, v62, s20, v9
    v_fma_f32 v111, v63, s20, v9
    s_and_b32 s27, s27, s29
    s_bitcmp1_b32 s29, 0
    s_cbranch_scc1 L_rm0_l
    v_mov_b32 v10, 1.0
L_rm0_l:
    s_bitcmp1_b32 s29, 1
    s_cbranch_scc1 L_rm1_l
    v_mov_b32 v11, 1.0
L_rm1_l:
    s_bitcmp1_b32 s29, 2
    s_cbranch_scc1 L_rm2_l
    v_mov_b32 v12, 1.0
L_rm2_l:
    s_or_b32 s29, s29, 7
    s_branch L_back0_l0
L_rare1_l0:
    v_max3_f32 v14, v32, v33, v34
    v_max3_f32 v14, v14, v35, v36
    v_max3_f32 v14, v14, v37, v38
    v_max_f32 v14, v14, v39
    v_mov_b32 v15, v14
    s_nop 1
    v_permlane32_swap_b32 v15, v14
    s_nop 0
    v_max_f32 v14, v14, v15
    v_mov_b32 v15, v14
    s_nop 1
    v_permlane16_swap_b32 v15, v14
    s_nop 0
    v_max_f32 v14, v14, v15
    v_mul_f32 v14, 0xbdb8aa3b, v14
    v_sub_f32 v15, v7, v14
    v_cmp_lt_f32 vcc, 0x41000000, v15
    s_nop 1
    v_cndmask_b32 v14, v7, v14, vcc
    v_sub_f32 v15, v14, v7
    v_exp_f32 v15, v15
    v_mov_b32 v7, v14
    v_mul_f32 v10, v10, v15
    s_cmp_lg_u64 vcc, 0
    s_cselect_b32 s47, 1, 0
    s_or_b32 s27, s27, s47
    v_fma_f32 v80, v32, s20, v7
    v_fma_f32 v81, v33, s20, v7
    v_fma_f32 v82, v34, s20, v7
    v_fma_f32 v83, v35, s20, v7
    v_fma_f32 v84, v36, s20, v7
    v_fma_f32 v85, v37, s20, v7
    v_fma_f32 v86, v38, s20, v7
    v_fma_f32 v87, v39, s20, v7
    v_mul_f32 v72, v72, v15
    v_mul_f32 v73, v73, v15
    v_mul_f32 v74, v74, v15
    v_mul_f32 v75, v75, v15
    v_mul_f32 v76, v76, v15
    v_mul_f32 v77, v77, v15
    v_mul_f32 v78, v78, v15
    v_mul_f32 v79, v79, v15
    v_max3_f32 v14, v48, v49, v50
    v_max3_f32 v14, v14, v51, v52
    v_max3_f32 v14, v14, v53, v54
    v_max_f32 v14, v14, v55
    v_mov_b32 v15, v14
    s_nop 1
    v_permlane32_swap_b32 v15, v14
    s_nop 0
    v_max_f32 v14, v14, v15
    v_mov_b32 v15, v14
    s_nop 1
    v_permlane16_swap_b32 v15, v14
    s_nop 0
    v_max_f32 v14, v14, v15
    v_mul_f32 v14, 0xbdb8aa3b, v14
    v_sub_f32 v15, v8, v14
    v_cmp_lt_f32 vcc, 0x41000000, v15
    s_nop 1
    v_cndmask_b32 v14, v8, v14, vcc
    v_sub_f32 v15, v14, v8
    v_exp_f32 v15, v15
    v_mov_b32 v8, v14
    v_mul_f32 v11, v11, v15
    s_cmp_lg_u64 vcc, 0
    s_cselect_b32 s47, 2, 0
    s_or_b32 s27, s27, s47
    v_fma_f32 v96, v48, s20, v8
    v_fma_f32 v97, v49, s20, v8
    v_fma_f32 v98, v50, s20, v8
    v_fma_f32 v99, v51, s20, v8
    v_fma_f32 v100, v52, s20, v8
    v_fma_f32 v101, v53, s20, v8
    v_fma_f32 v102, v54, s20, v8
    v_fma_f32 v103, v55, s20, v8
    v_mul_f32 v88, v88, v15
    v_mul_f32 v89, v89, v15
    v_mul_f32 v90, v90, v15
    v_mul_f32 v91, v91, v15
    v_mul_f32 v92, v92, v15
    v_mul_f32 v93, v93, v15
    v_mul_f32 v94, v94, v15
    v_mul_f32 v95, v95, v15
    v_max3_f32 v14, v64, v65, v66
    v_max3_f32 v14, v14, v67, v68
    v_max3_f32 v14, v14, v69, v70
    v_max_f32 v14, v14, v71
    v_mov_b32 v15, v14
    s_nop 1
    v_permlane32_swap_b32 v15, v14
    s_nop 0
    v_max_f32 v14, v14, v15
    v_mov_b32 v15, v14
    s_nop 1
    v_permlane16_swap_b32 v15, v14
    s_nop 0
    v_max_f32 v14, v14, v15
    v_mul_f32 v14, 0xbdb8aa3b, v14
    v_sub_f32 v15, v9, v14
    v_cmp_lt_f32 vcc, 0x41000000, v15
    s_nop 1
    v_cndmask_b32 v14, v9, v14, vcc
    v_sub_f32 v15, v14, v9
    v_exp_f32 v15, v15
    v_mov_b32 v9, v14
    v_mul_f32 v12, v12, v15
    s_cmp_lg_u64 vcc, 0
    s_cselect_b32 s47, 4, 0
    s_or_b32 s27, s27, s47
    v_fma_f32 v112, v64, s20, v9
    v_fma_f32 v113, v65, s20, v9
    v_fma_f32 v114, v66, s20, v9
    v_fma_f32 v115, v67, s20, v9
    v_fma_f32 v116, v68, s20, v9
    v_fma_f32 v117, v69, s20, v9
    v_fma_f32 v118, v70, s20, v9
    v_fma_f32 v119, v71, s20, v9
    v_mul_f32 v104, v104, v15
    v_mul_f32 v105, v105, v15
    v_mul_f32 v106, v106, v15
    v_mul_f32 v107, v107, v15
    v_mul_f32 v108, v108, v15
    v_mul_f32 v109, v109, v15
    v_mul_f32 v110, v110, v15
    v_mul_f32 v111, v111, v15
    s_branch L_back1_l0
L_rare0_z0:
    v_max3_f32 v14, v24, v25, v26
    v_max3_f32 v14, v14, v27, v28
    v_max3_f32 v14, v14, v29, v30
    v_max_f32 v14, v14, v31
    v_mov_b32 v15, v14
    s_nop 1
    v_permlane32_swap_b32 v15, v14
    s_nop 0
    v_max_f32 v14, v14, v15
    v_mov_b32 v15, v14
    s_nop 1
    v_permlane16_swap_b32 v15, v14
    s_nop 0
    v_max_f32 v14, v14, v15
    v_mul_f32 v14, 0xbdb8aa3b, v14
    v_sub_f32 v15, v7, v14
    v_cmp_lt_f32 vcc, 0x41000000, v15
    s_nop 1
    v_cndmask_b32 v14, v7, v14, vcc
    v_sub_f32 v15, v14, v7
    v_exp_f32 v15, v15
    v_mov_b32 v7, v14
    v_mul_f32 v10, v10, v15
    s_cmp_lg_u64 vcc, 0
    s_cselect_b32 s47, 1, 0
    s_or_b32 s27, s27, s47
    v_fma_f32 v72, v24, s20, v7
    v_fma_f32 v73, v25, s20, v7
    v_fma_f32 v74, v26, s20, v7
    v_fma_f32 v75, v27, s20, v7
    v_fma_f32 v76, v28, s20, v7
    v_fma_f32 v77, v29, s20, v7
    v_fma_f32 v78, v30, s20, v7
    v_fma_f32 v79, v31, s20, v7
    v_max3_f32 v14, v40, v41, v42
    v_max3_f32 v14, v14, v43, v44
    v_max3_f32 v14, v14, v45, v46
    v_max_f32 v14, v14, v47
    v_mov_b32 v15, v14
    s_nop 1
    v_permlane32_swap_b32 v15, v14
    s_nop 0
    v_max_f32 v14, v14, v15
    v_mov_b32 v15, v14
    s_nop 1
    v_permlane16_swap_b32 v15, v14
    s_nop 0
    v_max_f32 v14, v14, v15
    v_mul_f32 v14, 0xbdb8aa3b, v14
    v_sub_f32 v15, v8, v14
    v_cmp_lt_f32 vcc, 0x41000000, v15
    s_nop 1
    v_cndmask_b32 v14, v8, v14, vcc
    v_sub_f32 v15, v14, v8
    v_exp_f32 v15, v15
    v_mov_b32 v8, v14
    v_mul_f32 v11, v11, v15
    s_cmp_lg_u64 vcc, 0
    s_cselect_b32 s47, 2, 0
    s_or_b32 s27, s27, s47
    v_fma_f32 v88, v40, s20, v8
    v_fma_f32 v89, v41, s20, v8
    v_fma_f32 v90, v42, s20, v8
    v_fma_f32 v91, v43, s20, v8
    v_fma_f32 v92, v44, s20, v8
    v_fma_f32 v93, v45, s20, v8
    v_fma_f32 v94, v46, s20, v8
    v_fma_f32 v95, v47, s20, v8
    v_max3_f32 v14, v56, v57, v58
    v_max3_f32 v14, v14, v59, v60
    v_max3_f32 v14, v14, v61, v62
    v_max_f32 v14, v14, v63
    v_mov_b32 v15, v14
    s_nop 1
    v_permlane32_swap_b32 v15, v14
    s_nop 0
    v_max_f32 v14, v14, v15
    v_mov_b32 v15, v14
    s_nop 1
    v_permlane16_swap_b32 v15, v14
    s_nop 0
    v_max_f32 v14, v14, v15
    v_mul_f32 v14, 0xbdb8aa3b, v14
    v_sub_f32 v15, v9, v14
    v_cmp_lt_f32 vcc, 0x41000000, v15
    s_nop 1
    v_cndmask_b32 v14, v9, v14, vcc
    v_sub_f32 v15, v14, v9
    v_exp_f32 v15, v15
    v_mov_b32 v9, v14
    v_mul_f32 v12, v12, v15
    s_cmp_lg_u64 vcc, 0
    s_cselect_b32 s47, 4, 0
    s_or_b32 s27, s27, s47
    v_fma_f32 v104, v56, s20, v9
    v_fma_f32 v105, v57, s20, v9
    v_fma_f32 v106, v58, s20, v9
    v_fma_f32 v107, v59, s20, v9
    v_fma_f32 v108, v60, s20, v9
    v_fma_f32 v109, v61, s20, v9
    v_fma_f32 v110, v62, s20, v9
    v_fma_f32 v111, v63, s20, v9
    s_and_b32 s27, s27, s29
    s_bitcmp1_b32 s29, 0
    s_cbranch_scc1 L_rm0_z
    v_mov_b32 v10, 1.0
L_rm0_z:
    s_bitcmp1_b32 s29, 1
    s_cbranch_scc1 L_rm1_z
    v_mov_b32 v11, 1.0
L_rm1_z:
    s_bitcmp1_b32 s29, 2
    s_cbranch_scc1 L_rm2_z
    v_mov_b32 v12, 1.0
L_rm2_z:
    s_or_b32 s29, s29, 7
    s_branch L_back0_z0
L_rare1_z0:
    v_max3_f32 v14, v32, v33, v34
    v_max3_f32 v14, v14, v35, v36
    v_max3_f32 v14, v14, v37, v38
    v_max_f32 v14, v14, v39
    v_mov_b32 v15, v14
    s_nop 1
    v_permlane32_swap_b32 v15, v14
    s_nop 0
    v_max_f32 v14, v14, v15
    v_mov_b32 v15, v14
    s_nop 1
    v_permlane16_swap_b32 v15, v14
    s_nop 0
    v_max_f32 v14, v14, v15
    v_mul_f32 v14, 0xbdb8aa3b, v14
    v_sub_f32 v15, v7, v14
    v_cmp_lt_f32 vcc, 0x41000000, v15
    s_nop 1
    v_cndmask_b32 v14, v7, v14, vcc
    v_sub_f32 v15, v14, v7
    v_exp_f32 v15, v15
    v_mov_b32 v7, v14
    v_mul_f32 v10, v10, v15
    s_cmp_lg_u64 vcc, 0
    s_cselect_b32 s47, 1, 0
    s_or_b32 s27, s27, s47
    v_fma_f32 v80, v32, s20, v7
    v_fma_f32 v81, v33, s20, v7
    v_fma_f32 v82, v34, s20, v7
    v_fma_f32 v83, v35, s20, v7
    v_fma_f32 v84, v36, s20, v7
    v_fma_f32 v85, v37, s20, v7
    v_fma_f32 v86, v38, s20, v7
    v_fma_f32 v87, v39, s20, v7
    v_mul_f32 v72, v72, v15
    v_mul_f32 v73, v73, v15
    v_mul_f32 v74, v74, v15
    v_mul_f32 v75, v75, v15
    v_mul_f32 v76, v76, v15
    v_mul_f32 v77, v77, v15
    v_mul_f32 v78, v78, v15
    v_mul_f32 v79, v79, v15
    v_max3_f32 v14, v48, v49, v50
    v_max3_f32 v14, v14, v51, v52
    v_max3_f32 v14, v14, v53, v54
    v_max_f32 v14, v14, v55
    v_mov_b32 v15, v14
    s_nop 1
    v_permlane32_swap_b32 v15, v14
    s_nop 0
    v_max_f32 v14, v14, v15
    v_mov_b32 v15, v14
    s_nop 1
    v_permlane16_swap_b32 v15, v14
    s_nop 0
    v_max_f32 v14, v14, v15
    v_mul_f32 v14, 0xbdb8aa3b, v14
    v_sub_f32 v15, v8, v14
    v_cmp_lt_f32 vcc, 0x41000000, v15
    s_nop 1
    v_cndmask_b32 v14, v8, v14, vcc
    v_sub_f32 v15, v14, v8
    v_exp_f32 v15, v15
    v_mov_b32 v8, v14
    v_mul_f32 v11, v11, v15
    s_cmp_lg_u64 vcc, 0
    s_cselect_b32 s47, 2, 0
    s_or_b32 s27, s27, s47
    v_fma_f32 v96, v48, s20, v8
    v_fma_f32 v97, v49, s20, v8
    v_fma_f32 v98, v50, s20, v8
    v_fma_f32 v99, v51, s20, v8
    v_fma_f32 v100, v52, s20, v8
    v_fma_f32 v101, v53, s20, v8
    v_fma_f32 v102, v54, s20, v8
    v_fma_f32 v103, v55, s20, v8
    v_mul_f32 v88, v88, v15
    v_mul_f32 v89, v89, v15
    v_mul_f32 v90, v90, v15
    v_mul_f32 v91, v91, v15
    v_mul_f32 v92, v92, v15
    v_mul_f32 v93, v93, v15
    v_mul_f32 v94, v94, v15
    v_mul_f32 v95, v95, v15
    v_max3_f32 v14, v64, v65, v66
    v_max3_f32 v14, v14, v67, v68
    v_max3_f32 v14, v14, v69, v70
    v_max_f32 v14, v14, v71
    v_mov_b32 v15, v14
    s_nop 1
    v_permlane32_swap_b32 v15, v14
    s_nop 0
    v_max_f32 v14, v14, v15
    v_mov_b32 v15, v14
    s_nop 1
    v_permlane16_swap_b32 v15, v14
    s_nop 0
    v_max_f32 v14, v14, v15
    v_mul_f32 v14, 0xbdb8aa3b, v14
    v_sub_f32 v15, v9, v14
    v_cmp_lt_f32 vcc, 0x41000000, v15
    s_nop 1
    v_cndmask_b32 v14, v9, v14, vcc
    v_sub_f32 v15, v14, v9
    v_exp_f32 v15, v15
    v_mov_b32 v9, v14
    v_mul_f32 v12, v12, v15
    s_cmp_lg_u64 vcc, 0
    s_cselect_b32 s47, 4, 0
    s_or_b32 s27, s27, s47
    v_fma_f32 v112, v64, s20, v9
    v_fma_f32 v113, v65, s20, v9
    v_fma_f32 v114, v66, s20, v9
    v_fma_f32 v115, v67, s20, v9
    v_fma_f32 v116, v68, s20, v9
    v_fma_f32 v117, v69, s20, v9
    v_fma_f32 v118, v70, s20, v9
    v_fma_f32 v119, v71, s20, v9
    v_mul_f32 v104, v104, v15
    v_mul_f32 v105, v105, v15
    v_mul_f32 v106, v106, v15
    v_mul_f32 v107, v107, v15
    v_mul_f32 v108, v108, v15
    v_mul_f32 v109, v109, v15
    v_mul_f32 v110, v110, v15
    v_mul_f32 v111, v111, v15
    s_branch L_back1_z0
L_resc_z:
    s_nop 15
    s_bitcmp1_b32 s27, 0
    s_cbranch_scc0 L_zp0
    v_lshlrev_b32 v14, 16, v120
    v_and_b32 v15, 0xffff0000, v120
    v_mul_f32 v14, v14, v10
    v_mul_f32 v15, v15, v10
    v_cvt_pk_bf16_f32 v120, v14, v15
    v_lshlrev_b32 v14, 16, v121
    v_and_b32 v15, 0xffff0000, v121
    v_mul_f32 v14, v14, v10
    v_mul_f32 v15, v15, v10
    v_cvt_pk_bf16_f32 v121, v14, v15
    v_lshlrev_b32 v14, 16, v122
    v_and_b32 v15, 0xffff0000, v122
    v_mul_f32 v14, v14, v10
    v_mul_f32 v15, v15, v10
    v_cvt_pk_bf16_f32 v122, v14, v15
    v_lshlrev_b32 v14, 16, v123
    v_and_b32 v15, 0xffff0000, v123
    v_mul_f32 v14, v14, v10
    v_mul_f32 v15, v15, v10
    v_cvt_pk_bf16_f32 v123, v14, v15
    v_lshlrev_b32 v14, 16, v124
    v_and_b32 v15, 0xffff0000, v124
    v_mul_f32 v14, v14, v10
    v_mul_f32 v15, v15, v10
    v_cvt_pk_bf16_f32 v124, v14, v15
    v_lshlrev_b32 v14, 16, v125
    v_and_b32 v15, 0xffff0000, v125
    v_mul_f32 v14, v14, v10
    v_mul_f32 v15, v15, v10
    v_cvt_pk_bf16_f32 v125, v14, v15
    v_lshlrev_b32 v14, 16, v126
    v_and_b32 v15, 0xffff0000, v126
    v_mul_f32 v14, v14, v10
    v_mul_f32 v15, v15, v10
    v_cvt_pk_bf16_f32 v126, v14, v15
    v_lshlrev_b32 v14, 16, v127
    v_and_b32 v15, 0xffff0000, v127
    v_mul_f32 v14, v14, v10
    v_mul_f32 v15, v15, v10
    v_cvt_pk_bf16_f32 v127, v14, v15
L_zp0:
    s_bitcmp1_b32 s27, 1
    s_cbranch_scc0 L_zp1
    v_lshlrev_b32 v14, 16, v128
    v_and_b32 v15, 0xffff0000, v128
    v_mul_f32 v14, v14, v11
    v_mul_f32 v15, v15, v11
    v_cvt_pk_bf16_f32 v128, v14, v15
    v_lshlrev_b32 v14, 16, v129
    v_and_b32 v15, 0xffff0000, v129
    v_mul_f32 v14, v14, v11
    v_mul_f32 v15, v15, v11
    v_cvt_pk_bf16_f32 v129, v14, v15
    v_lshlrev_b32 v14, 16, v130
    v_and_b32 v15, 0xffff0000, v130
    v_mul_f32 v14, v14, v11
    v_mul_f32 v15, v15, v11
    v_cvt_pk_bf16_f32 v130, v14, v15
    v_lshlrev_b32 v14, 16, v131
    v_and_b32 v15, 0xffff0000, v131
    v_mul_f32 v14, v14, v11
    v_mul_f32 v15, v15, v11
    v_cvt_pk_bf16_f32 v131, v14, v15
    v_lshlrev_b32 v14, 16, v132
    v_and_b32 v15, 0xffff0000, v132
    v_mul_f32 v14, v14, v11
    v_mul_f32 v15, v15, v11
    v_cvt_pk_bf16_f32 v132, v14, v15
    v_lshlrev_b32 v14, 16, v133
    v_and_b32 v15, 0xffff0000, v133
    v_mul_f32 v14, v14, v11
    v_mul_f32 v15, v15, v11
    v_cvt_pk_bf16_f32 v133, v14, v15
    v_lshlrev_b32 v14, 16, v134
    v_and_b32 v15, 0xffff0000, v134
    v_mul_f32 v14, v14, v11
    v_mul_f32 v15, v15, v11
    v_cvt_pk_bf16_f32 v134, v14, v15
    v_lshlrev_b32 v14, 16, v135
    v_and_b32 v15, 0xffff0000, v135
    v_mul_f32 v14, v14, v11
    v_mul_f32 v15, v15, v11
    v_cvt_pk_bf16_f32 v135, v14, v15
L_zp1:
    s_bitcmp1_b32 s27, 2
    s_cbranch_scc0 L_zp2
    v_lshlrev_b32 v14, 16, v136
    v_and_b32 v15, 0xffff0000, v136
    v_mul_f32 v14, v14, v12
    v_mul_f32 v15, v15, v12
    v_cvt_pk_bf16_f32 v136, v14, v15
    v_lshlrev_b32 v14, 16, v137
    v_and_b32 v15, 0xffff0000, v137
    v_mul_f32 v14, v14, v12
    v_mul_f32 v15, v15, v12
    v_cvt_pk_bf16_f32 v137, v14, v15
    v_lshlrev_b32 v14, 16, v138
    v_and_b32 v15, 0xffff0000, v138
    v_mul_f32 v14, v14, v12
    v_mul_f32 v15, v15, v12
    v_cvt_pk_bf16_f32 v138, v14, v15
    v_lshlrev_b32 v14, 16, v139
    v_and_b32 v15, 0xffff0000, v139
    v_mul_f32 v14, v14, v12
    v_mul_f32 v15, v15, v12
    v_cvt_pk_bf16_f32 v139, v14, v15
    v_lshlrev_b32 v14, 16, v140
    v_and_b32 v15, 0xffff0000, v140
    v_mul_f32 v14, v14, v12
    v_mul_f32 v15, v15, v12
    v_cvt_pk_bf16_f32 v140, v14, v15
    v_lshlrev_b32 v14, 16, v141
    v_and_b32 v15, 0xffff0000, v141
    v_mul_f32 v14, v14, v12
    v_mul_f32 v15, v15, v12
    v_cvt_pk_bf16_f32 v141, v14, v15
    v_lshlrev_b32 v14, 16, v142
    v_and_b32 v15, 0xffff0000, v142
    v_mul_f32 v14, v14, v12
    v_mul_f32 v15, v15, v12
    v_cvt_pk_bf16_f32 v142, v14, v15
    v_lshlrev_b32 v14, 16, v143
    v_and_b32 v15, 0xffff0000, v143
    v_mul_f32 v14, v14, v12
    v_mul_f32 v15, v15, v12
    v_cvt_pk_bf16_f32 v143, v14, v15
L_zp2:
    s_call_b64 s[30:31], L_resc
    s_branch L_rescback_z
L_resc:
    s_nop 15
    s_bitcmp1_b32 s27, 0
    s_cbranch_scc0 L_resc0
    v_mul_f32 v192, v192, v10
    v_mul_f32 v193, v193, v10
    v_mul_f32 v194, v194, v10
    v_mul_f32 v195, v195, v10
    v_mul_f32 v196, v196, v10
    v_mul_f32 v197, v197, v10
    v_mul_f32 v198, v198, v10
    v_mul_f32 v199, v199, v10
    v_mul_f32 v200, v200, v10
    v_mul_f32 v201, v201, v10
    v_mul_f32 v202, v202, v10
    v_mul_f32 v203, v203, v10
    v_mul_f32 v204, v204, v10
    v_mul_f32 v205, v205, v10
    v_mul_f32 v206, v206, v10
    v_mul_f32 v207, v207, v10
    v_mul_f32 v208, v208, v10
    v_mul_f32 v209, v209, v10
    v_mul_f32 v210, v210, v10
    v_mul_f32 v211, v211, v10
    v_mul_f32 v212, v212, v10
    v_mul_f32 v213, v213, v10
    v_mul_f32 v214, v214, v10
    v_mul_f32 v215, v215, v10
    v_mul_f32 v216, v216, v10
    v_mul_f32 v217, v217, v10
    v_mul_f32 v218, v218, v10
    v_mul_f32 v219, v219, v10
    v_mul_f32 v220, v220, v10
    v_mul_f32 v221, v221, v10
    v_mul_f32 v222, v222, v10
    v_mul_f32 v223, v223, v10
    v_mul_f32 v224, v224, v10
    v_mul_f32 v225, v225, v10
    v_mul_f32 v226, v226, v10
    v_mul_f32 v227, v227, v10
    v_mul_f32 v228, v228, v10
    v_mul_f32 v229, v229, v10
    v_mul_f32 v230, v230, v10
    v_mul_f32 v231, v231, v10
    v_mul_f32 v232, v232, v10
    v_mul_f32 v233, v233, v10
    v_mul_f32 v234, v234, v10
    v_mul_f32 v235, v235, v10
    v_mul_f32 v236, v236, v10
    v_mul_f32 v237, v237, v10
    v_mul_f32 v238, v238, v10
    v_mul_f32 v239, v239, v10
    v_mul_f32 v240, v240, v10
    v_mul_f32 v241, v241, v10
    v_mul_f32 v242, v242, v10
    v_mul_f32 v243, v243, v10
    v_mul_f32 v244, v244, v10
    v_mul_f32 v245, v245, v10
    v_mul_f32 v246, v246, v10
    v_mul_f32 v247, v247, v10
    v_mul_f32 v248, v248, v10
    v_mul_f32 v249, v249, v10
    v_mul_f32 v250, v250, v10
    v_mul_f32 v251, v251, v10
    v_mul_f32 v252, v252, v10
    v_mul_f32 v253, v253, v10
    v_mul_f32 v254, v254, v10
    v_mul_f32 v255, v255, v10
    v_accvgpr_read_b32 v14, a224
    v_mul_f32 v14, v14, v10
    v_accvgpr_write_b32 a224, v14
    v_accvgpr_read_b32 v14, a225
    v_mul_f32 v14, v14, v10
    v_accvgpr_write_b32 a225, v14
    v_accvgpr_read_b32 v14, a226
    v_mul_f32 v14, v14, v10
    v_accvgpr_write_b32 a226, v14
    v_accvgpr_read_b32 v14, a227
    v_mul_f32 v14, v14, v10
    v_accvgpr_write_b32 a227, v14
    v_mov_b32 v10, 1.0
L_resc0:
    s_bitcmp1_b32 s27, 1
    s_cbranch_scc0 L_resc1
    v_accvgpr_read_b32 v14, a96
    v_mul_f32 v14, v14, v11
    v_accvgpr_write_b32 a96, v14
    v_accvgpr_read_b32 v14, a97
    v_mul_f32 v14, v14, v11
    v_accvgpr_write_b32 a97, v14
    v_accvgpr_read_b32 v14, a98
    v_mul_f32 v14, v14, v11
    v_accvgpr_write_b32 a98, v14
    v_accvgpr_read_b32 v14, a99
    v_mul_f32 v14, v14, v11
    v_accvgpr_write_b32 a99, v14
    v_accvgpr_read_b32 v14, a100
    v_mul_f32 v14, v14, v11
    v_accvgpr_write_b32 a100, v14
    v_accvgpr_read_b32 v14, a101
    v_mul_f32 v14, v14, v11
    v_accvgpr_write_b32 a101, v14
    v_accvgpr_read_b32 v14, a102
    v_mul_f32 v14, v14, v11
    v_accvgpr_write_b32 a102, v14
    v_accvgpr_read_b32 v14, a103
    v_mul_f32 v14, v14, v11
    v_accvgpr_write_b32 a103, v14
    v_accvgpr_read_b32 v14, a104
    v_mul_f32 v14, v14, v11
    v_accvgpr_write_b32 a104, v14
    v_accvgpr_read_b32 v14, a105
    v_mul_f32 v14, v14, v11
    v_accvgpr_write_b32 a105, v14
    v_accvgpr_read_b32 v14, a106
    v_mul_f32 v14, v14, v11
    v_accvgpr_write_b32 a106, v14
    v_accvgpr_read_b32 v14, a107
    v_mul_f32 v14, v14, v11
    v_accvgpr_write_b32 a107, v14
    v_accvgpr_read_b32 v14, a108
    v_mul_f32 v14, v14, v11
    v_accvgpr_write_b32 a108, v14
    v_accvgpr_read_b32 v14, a109
    v_mul_f32 v14, v14, v11
    v_accvgpr_write_b32 a109, v14
    v_accvgpr_read_b32 v14, a110
    v_mul_f32 v14, v14, v11
    v_accvgpr_write_b32 a110, v14
    v_accvgpr_read_b32 v14, a111
    v_mul_f32 v14, v14, v11
    v_accvgpr_write_b32 a111, v14
    v_accvgpr_read_b32 v14, a112
    v_mul_f32 v14, v14, v11
    v_accvgpr_write_b32 a112, v14
    v_accvgpr_read_b32 v14, a113
    v_mul_f32 v14, v14, v11
    v_accvgpr_write_b32 a113, v14
    v_accvgpr_read_b32 v14, a114
    v_mul_f32 v14, v14, v11
    v_accvgpr_write_b32 a114, v14
    v_accvgpr_read_b32 v14, a115
    v_mul_f32 v14, v14, v11
    v_accvgpr_write_b32 a115, v14
    v_accvgpr_read_b32 v14, a116
    v_mul_f32 v14, v14, v11
    v_accvgpr_write_b32 a116, v14
    v_accvgpr_read_b32 v14, a117
    v_mul_f32 v14, v14, v11
    v_accvgpr_write_b32 a117, v14
    v_accvgpr_read_b32 v14, a118
    v_mul_f32 v14, v14, v11
    v_accvgpr_write_b32 a118, v14
    v_accvgpr_read_b32 v14, a119
    v_mul_f32 v14, v14, v11
    v_accvgpr_write_b32 a119, v14
    v_accvgpr_read_b32 v14, a120
    v_mul_f32 v14, v14, v11
    v_accvgpr_write_b32 a120, v14
    v_accvgpr_read_b32 v14, a121
    v_mul_f32 v14, v14, v11
    v_accvgpr_write_b32 a121, v14
    v_accvgpr_read_b32 v14, a122
    v_mul_f32 v14, v14, v11
    v_accvgpr_write_b32 a122, v14
    v_accvgpr_read_b32 v14, a123
    v_mul_f32 v14, v14, v11
    v_accvgpr_write_b32 a123, v14
    v_accvgpr_read_b32 v14, a124
    v_mul_f32 v14, v14, v11
    v_accvgpr_write_b32 a124, v14
    v_accvgpr_read_b32 v14, a125
    v_mul_f32 v14, v14, v11
    v_accvgpr_write_b32 a125, v14
    v_accvgpr_read_b32 v14, a126
    v_mul_f32 v14, v14, v11
    v_accvgpr_write_b32 a126, v14
    v_accvgpr_read_b32 v14, a127
    v_mul_f32 v14, v14, v11
    v_accvgpr_write_b32 a127, v14
    v_accvgpr_read_b32 v14, a128
    v_mul_f32 v14, v14, v11
    v_accvgpr_write_b32 a128, v14
    v_accvgpr_read_b32 v14, a129
    v_mul_f32 v14, v14, v11
    v_accvgpr_write_b32 a129, v14
    v_accvgpr_read_b32 v14, a130
    v_mul_f32 v14, v14, v11
    v_accvgpr_write_b32 a130, v14
    v_accvgpr_read_b32 v14, a131
    v_mul_f32 v14, v14, v11
    v_accvgpr_write_b32 a131, v14
    v_accvgpr_read_b32 v14, a132
    v_mul_f32 v14, v14, v11
    v_accvgpr_write_b32 a132, v14
    v_accvgpr_read_b32 v14, a133
    v_mul_f32 v14, v14, v11
    v_accvgpr_write_b32 a133, v14
    v_accvgpr_read_b32 v14, a134
    v_mul_f32 v14, v14, v11
    v_accvgpr_write_b32 a134, v14
    v_accvgpr_read_b32 v14, a135
    v_mul_f32 v14, v14, v11
    v_accvgpr_write_b32 a135, v14
    v_accvgpr_read_b32 v14, a136
    v_mul_f32 v14, v14, v11
    v_accvgpr_write_b32 a136, v14
    v_accvgpr_read_b32 v14, a137
    v_mul_f32 v14, v14, v11
    v_accvgpr_write_b32 a137, v14
    v_accvgpr_read_b32 v14, a138
    v_mul_f32 v14, v14, v11
    v_accvgpr_write_b32 a138, v14
    v_accvgpr_read_b32 v14, a139
    v_mul_f32 v14, v14, v11
    v_accvgpr_write_b32 a139, v14
    v_accvgpr_read_b32 v14, a140
    v_mul_f32 v14, v14, v11
    v_accvgpr_write_b32 a140, v14
    v_accvgpr_read_b32 v14, a141
    v_mul_f32 v14, v14, v11
    v_accvgpr_write_b32 a141, v14
    v_accvgpr_read_b32 v14, a142
    v_mul_f32 v14, v14, v11
    v_accvgpr_write_b32 a142, v14
    v_accvgpr_read_b32 v14, a143
    v_mul_f32 v14, v14, v11
    v_accvgpr_write_b32 a143, v14
    v_accvgpr_read_b32 v14, a144
    v_mul_f32 v14, v14, v11
    v_accvgpr_write_b32 a144, v14
    v_accvgpr_read_b32 v14, a145
    v_mul_f32 v14, v14, v11
    v_accvgpr_write_b32 a145, v14
    v_accvgpr_read_b32 v14, a146
    v_mul_f32 v14, v14, v11
    v_accvgpr_write_b32 a146, v14
    v_accvgpr_read_b32 v14, a147
    v_mul_f32 v14, v14, v11
    v_accvgpr_write_b32 a147, v14
    v_accvgpr_read_b32 v14, a148
    v_mul_f32 v14, v14, v11
    v_accvgpr_write_b32 a148, v14
    v_accvgpr_read_b32 v14, a149
    v_mul_f32 v14, v14, v11
    v_accvgpr_write_b32 a149, v14
    v_accvgpr_read_b32 v14, a150
    v_mul_f32 v14, v14, v11
    v_accvgpr_write_b32 a150, v14
    v_accvgpr_read_b32 v14, a151
    v_mul_f32 v14, v14, v11
    v_accvgpr_write_b32 a151, v14
    v_accvgpr_read_b32 v14, a152
    v_mul_f32 v14, v14, v11
    v_accvgpr_write_b32 a152, v14
    v_accvgpr_read_b32 v14, a153
    v_mul_f32 v14, v14, v11
    v_accvgpr_write_b32 a153, v14
    v_accvgpr_read_b32 v14, a154
    v_mul_f32 v14, v14, v11
    v_accvgpr_write_b32 a154, v14
    v_accvgpr_read_b32 v14, a155
    v_mul_f32 v14, v14, v11
    v_accvgpr_write_b32 a155, v14
    v_accvgpr_read_b32 v14, a156
    v_mul_f32 v14, v14, v11
    v_accvgpr_write_b32 a156, v14
    v_accvgpr_read_b32 v14, a157
    v_mul_f32 v14, v14, v11
    v_accvgpr_write_b32 a157, v14
    v_accvgpr_read_b32 v14, a158
    v_mul_f32 v14, v14, v11
    v_accvgpr_write_b32 a158, v14
    v_accvgpr_read_b32 v14, a159
    v_mul_f32 v14, v14, v11
    v_accvgpr_write_b32 a159, v14
    v_accvgpr_read_b32 v14, a228
    v_mul_f32 v14, v14, v11
    v_accvgpr_write_b32 a228, v14
    v_accvgpr_read_b32 v14, a229
    v_mul_f32 v14, v14, v11
    v_accvgpr_write_b32 a229, v14
    v_accvgpr_read_b32 v14, a230
    v_mul_f32 v14, v14, v11
    v_accvgpr_write_b32 a230, v14
    v_accvgpr_read_b32 v14, a231
    v_mul_f32 v14, v14, v11
    v_accvgpr_write_b32 a231, v14
    v_mov_b32 v11, 1.0
L_resc1:
    s_bitcmp1_b32 s27, 2
    s_cbranch_scc0 L_resc2
    v_accvgpr_read_b32 v14, a160
    v_mul_f32 v14, v14, v12
    v_accvgpr_write_b32 a160, v14
    v_accvgpr_read_b32 v14, a161
    v_mul_f32 v14, v14, v12
    v_accvgpr_write_b32 a161, v14
    v_accvgpr_read_b32 v14, a162
    v_mul_f32 v14, v14, v12
    v_accvgpr_write_b32 a162, v14
    v_accvgpr_read_b32 v14, a163
    v_mul_f32 v14, v14, v12
    v_accvgpr_write_b32 a163, v14
    v_accvgpr_read_b32 v14, a164
    v_mul_f32 v14, v14, v12
    v_accvgpr_write_b32 a164, v14
    v_accvgpr_read_b32 v14, a165
    v_mul_f32 v14, v14, v12
    v_accvgpr_write_b32 a165, v14
    v_accvgpr_read_b32 v14, a166
    v_mul_f32 v14, v14, v12
    v_accvgpr_write_b32 a166, v14
    v_accvgpr_read_b32 v14, a167
    v_mul_f32 v14, v14, v12
    v_accvgpr_write_b32 a167, v14
    v_accvgpr_read_b32 v14, a168
    v_mul_f32 v14, v14, v12
    v_accvgpr_write_b32 a168, v14
    v_accvgpr_read_b32 v14, a169
    v_mul_f32 v14, v14, v12
    v_accvgpr_write_b32 a169, v14
    v_accvgpr_read_b32 v14, a170
    v_mul_f32 v14, v14, v12
    v_accvgpr_write_b32 a170, v14
    v_accvgpr_read_b32 v14, a171
    v_mul_f32 v14, v14, v12
    v_accvgpr_write_b32 a171, v14
    v_accvgpr_read_b32 v14, a172
    v_mul_f32 v14, v14, v12
    v_accvgpr_write_b32 a172, v14
    v_accvgpr_read_b32 v14, a173
    v_mul_f32 v14, v14, v12
    v_accvgpr_write_b32 a173, v14
    v_accvgpr_read_b32 v14, a174
    v_mul_f32 v14, v14, v12
    v_accvgpr_write_b32 a174, v14
    v_accvgpr_read_b32 v14, a175
    v_mul_f32 v14, v14, v12
    v_accvgpr_write_b32 a175, v14
    v_accvgpr_read_b32 v14, a176
    v_mul_f32 v14, v14, v12
    v_accvgpr_write_b32 a176, v14
    v_accvgpr_read_b32 v14, a177
    v_mul_f32 v14, v14, v12
    v_accvgpr_write_b32 a177, v14
    v_accvgpr_read_b32 v14, a178
    v_mul_f32 v14, v14, v12
    v_accvgpr_write_b32 a178, v14
    v_accvgpr_read_b32 v14, a179
    v_mul_f32 v14, v14, v12
    v_accvgpr_write_b32 a179, v14
    v_accvgpr_read_b32 v14, a180
    v_mul_f32 v14, v14, v12
    v_accvgpr_write_b32 a180, v14
    v_accvgpr_read_b32 v14, a181
    v_mul_f32 v14, v14, v12
    v_accvgpr_write_b32 a181, v14
    v_accvgpr_read_b32 v14, a182
    v_mul_f32 v14, v14, v12
    v_accvgpr_write_b32 a182, v14
    v_accvgpr_read_b32 v14, a183
    v_mul_f32 v14, v14, v12
    v_accvgpr_write_b32 a183, v14
    v_accvgpr_read_b32 v14, a184
    v_mul_f32 v14, v14, v12
    v_accvgpr_write_b32 a184, v14
    v_accvgpr_read_b32 v14, a185
    v_mul_f32 v14, v14, v12
    v_accvgpr_write_b32 a185, v14
    v_accvgpr_read_b32 v14, a186
    v_mul_f32 v14, v14, v12
    v_accvgpr_write_b32 a186, v14
    v_accvgpr_read_b32 v14, a187
    v_mul_f32 v14, v14, v12
    v_accvgpr_write_b32 a187, v14
    v_accvgpr_read_b32 v14, a188
    v_mul_f32 v14, v14, v12
    v_accvgpr_write_b32 a188, v14
    v_accvgpr_read_b32 v14, a189
    v_mul_f32 v14, v14, v12
    v_accvgpr_write_b32 a189, v14
    v_accvgpr_read_b32 v14, a190
    v_mul_f32 v14, v14, v12
    v_accvgpr_write_b32 a190, v14
    v_accvgpr_read_b32 v14, a191
    v_mul_f32 v14, v14, v12
    v_accvgpr_write_b32 a191, v14
    v_accvgpr_read_b32 v14, a192
    v_mul_f32 v14, v14, v12
    v_accvgpr_write_b32 a192, v14
    v_accvgpr_read_b32 v14, a193
    v_mul_f32 v14, v14, v12
    v_accvgpr_write_b32 a193, v14
    v_accvgpr_read_b32 v14, a194
    v_mul_f32 v14, v14, v12
    v_accvgpr_write_b32 a194, v14
    v_accvgpr_read_b32 v14, a195
    v_mul_f32 v14, v14, v12
    v_accvgpr_write_b32 a195, v14
    v_accvgpr_read_b32 v14, a196
    v_mul_f32 v14, v14, v12
    v_accvgpr_write_b32 a196, v14
    v_accvgpr_read_b32 v14, a197
    v_mul_f32 v14, v14, v12
    v_accvgpr_write_b32 a197, v14
    v_accvgpr_read_b32 v14, a198
    v_mul_f32 v14, v14, v12
    v_accvgpr_write_b32 a198, v14
    v_accvgpr_read_b32 v14, a199
    v_mul_f32 v14, v14, v12
    v_accvgpr_write_b32 a199, v14
    v_accvgpr_read_b32 v14, a200
    v_mul_f32 v14, v14, v12
    v_accvgpr_write_b32 a200, v14
    v_accvgpr_read_b32 v14, a201
    v_mul_f32 v14, v14, v12
    v_accvgpr_write_b32 a201, v14
    v_accvgpr_read_b32 v14, a202
    v_mul_f32 v14, v14, v12
    v_accvgpr_write_b32 a202, v14
    v_accvgpr_read_b32 v14, a203
    v_mul_f32 v14, v14, v12
    v_accvgpr_write_b32 a203, v14
    v_accvgpr_read_b32 v14, a204
    v_mul_f32 v14, v14, v12
    v_accvgpr_write_b32 a204, v14
    v_accvgpr_read_b32 v14, a205
    v_mul_f32 v14, v14, v12
    v_accvgpr_write_b32 a205, v14
    v_accvgpr_read_b32 v14, a206
    v_mul_f32 v14, v14, v12
    v_accvgpr_write_b32 a206, v14
    v_accvgpr_read_b32 v14, a207
    v_mul_f32 v14, v14, v12
    v_accvgpr_write_b32 a207, v14
    v_accvgpr_read_b32 v14, a208
    v_mul_f32 v14, v14, v12
    v_accvgpr_write_b32 a208, v14
    v_accvgpr_read_b32 v14, a209
    v_mul_f32 v14, v14, v12
    v_accvgpr_write_b32 a209, v14
    v_accvgpr_read_b32 v14, a210
    v_mul_f32 v14, v14, v12
    v_accvgpr_write_b32 a210, v14
    v_accvgpr_read_b32 v14, a211
    v_mul_f32 v14, v14, v12
    v_accvgpr_write_b32 a211, v14
    v_accvgpr_read_b32 v14, a212
    v_mul_f32 v14, v14, v12
    v_accvgpr_write_b32 a212, v14
    v_accvgpr_read_b32 v14, a213
    v_mul_f32 v14, v14, v12
    v_accvgpr_write_b32 a213, v14
    v_accvgpr_read_b32 v14, a214
    v_mul_f32 v14, v14, v12
    v_accvgpr_write_b32 a214, v14
    v_accvgpr_read_b32 v14, a215
    v_mul_f32 v14, v14, v12
    v_accvgpr_write_b32 a215, v14
    v_accvgpr_read_b32 v14, a216
    v_mul_f32 v14, v14, v12
    v_accvgpr_write_b32 a216, v14
    v_accvgpr_read_b32 v14, a217
    v_mul_f32 v14, v14, v12
    v_accvgpr_write_b32 a217, v14
    v_accvgpr_read_b32 v14, a218
    v_mul_f32 v14, v14, v12
    v_accvgpr_write_b32 a218, v14
    v_accvgpr_read_b32 v14, a219
    v_mul_f32 v14, v14, v12
    v_accvgpr_write_b32 a219, v14
    v_accvgpr_read_b32 v14, a220
    v_mul_f32 v14, v14, v12
    v_accvgpr_write_b32 a220, v14
    v_accvgpr_read_b32 v14, a221
    v_mul_f32 v14, v14, v12
    v_accvgpr_write_b32 a221, v14
    v_accvgpr_read_b32 v14, a222
    v_mul_f32 v14, v14, v12
    v_accvgpr_write_b32 a222, v14
    v_accvgpr_read_b32 v14, a223
    v_mul_f32 v14, v14, v12
    v_accvgpr_write_b32 a223, v14
    v_accvgpr_read_b32 v14, a232
    v_mul_f32 v14, v14, v12
    v_accvgpr_write_b32 a232, v14
    v_accvgpr_read_b32 v14, a233
    v_mul_f32 v14, v14, v12
    v_accvgpr_write_b32 a233, v14
    v_accvgpr_read_b32 v14, a234
    v_mul_f32 v14, v14, v12
    v_accvgpr_write_b32 a234, v14
    v_accvgpr_read_b32 v14, a235
    v_mul_f32 v14, v14, v12
    v_accvgpr_write_b32 a235, v14
    v_mov_b32 v12, 1.0
L_resc2:
    s_mov_b32 s27, 0
    s_nop 3
    s_setpc_b64 s[30:31]
.section .rodata,"a"
.p2align 6
.amdhsa_kernel standalone__gqa_softmax__near_ridge_kernel
  .amdhsa_next_free_vgpr 512
  .amdhsa_next_free_sgpr 102
  .amdhsa_accum_offset 256
  .amdhsa_group_segment_fixed_size 0
  .amdhsa_kernarg_size 48
  .amdhsa_user_sgpr_count 2
  .amdhsa_user_sgpr_kernarg_segment_ptr 1
  .amdhsa_system_sgpr_workgroup_id_x 1
.end_amdhsa_kernel
```
